```python
import torch

def _softmax(x, axis=-1):
    return torch.softmax(x, dim=axis)
def _gelu(x):
    return torch.nn.functional.gelu(x, approximate="tanh")
def _silu(x):
    return torch.nn.functional.silu(x)
def _sigmoid(x):
    return torch.sigmoid(x)
def _layernorm(x, axis=-1, eps=1e-5):
    m = x.mean(dim=axis, keepdim=True)
    v = x.var(dim=axis, keepdim=True, unbiased=False)
    return (x - m) / torch.sqrt(v + eps)
def _scatter_add(tgt, idx, src, axis=0):
    return tgt.clone().index_add_(axis, idx, src)
def _segment_sum(src, seg, n):
    out = torch.zeros((n,) + src.shape[1:], dtype=src.dtype)
    return out.index_add_(0, seg, src)
def _pad(x, pw):
    flat = tuple(v for pair in reversed(pw) for v in pair)
    return torch.nn.functional.pad(x, flat)

kernel_name = 'interleave_layers__grouped_kv_mqa__glu_gated_reglu__prompt'

def setup_inputs():

    _w = (lambda a: (lambda t: t.to(torch.bfloat16) if t.is_floating_point() else t)(torch.as_tensor(a)))
    def _A_setup():
        B, S, D, H = 1, 2048, 512, 32
        Dh = D // H
        return {
            "x": _w((lambda *s: torch.randn(*s, dtype=torch.bfloat16) * 0.05)(B, S, D)),
            "wq": _w((lambda *s: torch.randn(*s, dtype=torch.bfloat16) * 0.05)(D, H * Dh)),
            "wk": _w((lambda *s: torch.randn(*s, dtype=torch.bfloat16) * 0.05)(D, Dh)),
            "wv": _w((lambda *s: torch.randn(*s, dtype=torch.bfloat16) * 0.05)(D, Dh)),
            "wo": _w((lambda *s: torch.randn(*s, dtype=torch.bfloat16) * 0.05)(H * Dh, D)),
        }
    _A_in = _A_setup()

    def _B_setup():
        B, S, D, F = 1, 2048, 512, 1792
        return {
            "x": _w((lambda *s: torch.randn(*s, dtype=torch.bfloat16) * 0.05)(B, S, D)),
            "W_gate": _w((lambda *s: torch.randn(*s, dtype=torch.bfloat16) * 0.4)(D, F) * (2.0 / D) ** 0.5),
            "W_up": _w((lambda *s: torch.randn(*s, dtype=torch.bfloat16) * 0.4)(D, F) * (2.0 / D) ** 0.5),
            "W_down": _w((lambda *s: torch.randn(*s, dtype=torch.bfloat16) * 0.4)(F, D) * (1.0 / F) ** 0.5),
        }
    _B_in = _B_setup()

    return {
        "A_x": _A_in["x"],
        "A_wq": _A_in["wq"],
        "A_wk": _A_in["wk"],
        "A_wv": _A_in["wv"],
        "A_wo": _A_in["wo"],
        "B_x": _B_in["x"],
        "B_W_gate": _B_in["W_gate"],
        "B_W_up": _B_in["W_up"],
        "B_W_down": _B_in["W_down"],
    }

def reference(A_x, A_wq, A_wk, A_wv, A_wo, B_x, B_W_gate, B_W_up, B_W_down):
    def _A_ref(x, wq, wk, wv, wo):
        B, S, D = x.shape
        H = 32
        Dh = D // H
        q = (lambda x, *d: x.permute(*d))((x @ wq).reshape(B, S, H, Dh), 0, 2, 1, 3)
        k = x @ wk
        v = x @ wv
        scores = torch.einsum("bhqd,bkd->bhqk", q, k) * (Dh ** -0.5)
        p = _softmax(scores, axis=-1)
        o = torch.einsum("bhqk,bkd->bhqd", p, v)
        return (lambda x, *d: x.permute(*d))(o, 0, 2, 1, 3).reshape(B, S, H * Dh) @ wo

    def _B_ref(x, W_gate, W_up, W_down):
        gate = torch.einsum("bsd,df->bsf", x, W_gate)
        up = torch.einsum("bsd,df->bsf", x, W_up)
        gate = gate * (lambda x, dt: x.to(dt))(gate > 0, gate.dtype)
        h = gate * up
        return torch.einsum("bsf,fd->bsd", h, W_down)

    x = A_x
    x = x + _A_ref(_layernorm(x, axis=-1), A_wq, A_wk, A_wv, A_wo)
    x = x + _B_ref(_layernorm(x, axis=-1), B_W_gate, B_W_up, B_W_down)
    x = x + _A_ref(_layernorm(x, axis=-1), A_wq, A_wk, A_wv, A_wo)
    x = x + _B_ref(_layernorm(x, axis=-1), B_W_gate, B_W_up, B_W_down)
    return x
```

```asm
; @launch grid=(256,1,1) block=(512,1,1) lds=163840
.amdgcn_target "amdgcn-amd-amdhsa--gfx950"
.text
.globl interleave_layers__grouped_kv_mqa__glu_gated_reglu__prompt_kernel
.p2align 8
.type interleave_layers__grouped_kv_mqa__glu_gated_reglu__prompt_kernel,@function
interleave_layers__grouped_kv_mqa__glu_gated_reglu__prompt_kernel:
M_PC0:
    s_cmp_ge_u32 s2, 256
    s_cbranch_scc1 M_END
    s_load_dwordx16 s[64:79], s[0:1], 0
    s_load_dwordx2 s[80:81], s[0:1], 64
    s_load_dwordx2 s[6:7], s[0:1], 72
    s_load_dwordx2 s[82:83], s[0:1], 80
    s_load_dwordx2 s[4:5], s[0:1], 88
    s_lshr_b32 s30, s2, 3
    s_getpc_b64 s[84:85]
    s_mov_b32 s86, M_CODE_END - M_PC0 - 64
    s_mov_b32 s87, 0x20000
    s_lshl_b32 s31, s30, 11
    v_lshlrev_b32 v2, 2, v0
    buffer_load_dword v184, v2, s[84:87], s31 offen
    v_lshrrev_b32 v1, 6, v0
    v_mov_b32 v7, v0
    v_and_b32 v0, 63, v0
    v_readfirstlane_b32 s3, v1
    s_and_b32 s16, s2, 7
    s_lshl_b32 s16, s16, 5
    s_add_u32 s16, s16, s30
    s_lshr_b32 s19, s16, 2
    s_and_b32 s20, s16, 3
    v_and_b32 v2, 15, v0
    v_lshrrev_b32 v3, 4, v0
    v_lshlrev_b32 v255, 10, v2
    v_lshl_add_u32 v255, v3, 4, v255
    v_lshlrev_b32 v1, 4, v0
    s_lshl_b32 s30, s3, 11
    s_lshl_b32 s31, s19, 15
    s_lshl_b32 s32, s3, 7
    s_add_u32 s31, s31, s32
    s_mov_b32 s58, 2097152
    s_mov_b32 s59, 0x20000
    s_waitcnt lgkmcnt(0)
    s_mov_b32 s56, s64
    s_mov_b32 s57, s65
    s_add_u32 m0, s30, 0
    s_add_u32 s32, s31, 0
    buffer_load_dwordx4 v255, s[56:59], s32 offen lds
    s_add_u32 m0, s30, 1024
    s_add_u32 s32, s31, 64
    buffer_load_dwordx4 v255, s[56:59], s32 offen lds
    s_add_u32 m0, s30, 16384
    s_add_u32 s32, s31, 16384
    buffer_load_dwordx4 v255, s[56:59], s32 offen lds
    s_add_u32 m0, s30, 17408
    s_add_u32 s32, s31, 16448
    buffer_load_dwordx4 v255, s[56:59], s32 offen lds
    s_mov_b32 s40, s66
    s_mov_b32 s41, s67
    s_mov_b32 s42, 524288
    s_mov_b32 s43, 0x20000
    s_mov_b32 s44, s68
    s_mov_b32 s39, s69
    s_mov_b32 s46, s70
    s_mov_b32 s47, s71
    s_cmp_eq_u32 s20, 0
    s_cbranch_scc0 NOTKV_1
    s_cmp_ge_u32 s3, 4
    s_cselect_b32 s84, s70, s68
    s_cselect_b32 s85, s71, s69
    s_mov_b32 s86, 16384
    s_mov_b32 s87, 0x20000
    s_lshl_b32 s30, s3, 12
    s_add_u32 m0, s30, 131072
    s_and_b32 s31, s30, 0x3fff
    buffer_load_dwordx4 v1, s[84:87], s31 offen offset:0 lds
    buffer_load_dwordx4 v1, s[84:87], s31 offen offset:1024 lds
    buffer_load_dwordx4 v1, s[84:87], s31 offen offset:2048 lds
    buffer_load_dwordx4 v1, s[84:87], s31 offen offset:3072 lds
    s_add_u32 s55, s19, 192
    s_branch PJOIN_2
NOTKV_1:
    s_and_b32 s30, s19, 7
    s_mul_i32 s30, s30, 3
    s_add_u32 s30, s30, s20
    s_sub_u32 s30, s30, 1
    s_lshl_b32 s30, s30, 3
    s_add_u32 s30, s30, s3
    s_mul_i32 s31, s30, 3072
    buffer_load_dwordx4 v[184:187], v1, s[40:43], s31 offen offset:0
    buffer_load_dwordx4 v[184:187], v1, s[40:43], s31 offen offset:1024
    buffer_load_dwordx4 v[184:187], v1, s[40:43], s31 offen offset:2048
    s_bitcmp1_b32 s30, 4
    s_cselect_b32 s96, s46, s44
    s_cselect_b32 s97, s47, s39
    s_mov_b32 s98, 16384
    s_mov_b32 s99, 0x20000
    s_and_b32 s31, s30, 15
    s_lshl_b32 s31, s31, 10
    s_cmp_lt_u32 s30, 32
    s_cselect_b32 s31, s31, 16384
    buffer_load_dwordx4 v[184:187], v1, s[96:99], s31 offen
    s_mul_i32 s55, s19, 3
    s_add_u32 s55, s55, s20
    s_sub_u32 s55, s55, 1
PJOIN_2:
    s_cmp_ge_u32 s55, 208
    s_cbranch_scc1 ULKV_7
    s_cmp_ge_u32 s55, 192
    s_cbranch_scc1 ULQ_6
    s_cmp_ge_u32 s55, 176
    s_cbranch_scc1 ULO_8
    s_cmp_ge_u32 s55, 112
    s_cbranch_scc1 ULD_4
    s_bitcmp1_b32 s55, 0
    s_cselect_b32 s66, s78, s76
    s_cselect_b32 s67, s79, s77
    s_mov_b32 s84, s66
    s_mov_b32 s85, s67
    s_mov_b32 s86, 1835008
    s_mov_b32 s87, 0x20000
    s_mov_b32 s88, s66
    s_mov_b32 s89, s67
    s_mov_b32 s90, 1835008
    s_mov_b32 s91, 0x20000
    s_lshr_b32 s51, s55, 1
    s_lshl_b32 s51, s51, 6
    s_mov_b32 s32, 3584
    s_branch ULC_3
ULO_8:
    s_mov_b32 s84, s72
    s_mov_b32 s85, s73
    s_mov_b32 s86, 524288
    s_mov_b32 s87, 0x20000
    s_mov_b32 s88, s72
    s_mov_b32 s89, s73
    s_mov_b32 s90, 524288
    s_mov_b32 s91, 0x20000
    s_sub_u32 s51, s55, 176
    s_lshl_b32 s51, s51, 6
    s_mov_b32 s32, 1024
    s_branch ULC_3
ULQ_6:
    s_mov_b32 s84, s66
    s_mov_b32 s85, s67
    s_mov_b32 s86, 524288
    s_mov_b32 s87, 0x20000
    s_mov_b32 s88, s66
    s_mov_b32 s89, s67
    s_mov_b32 s90, 524288
    s_mov_b32 s91, 0x20000
    s_sub_u32 s51, s55, 192
    s_lshl_b32 s51, s51, 6
    s_mov_b32 s32, 1024
ULC_3:
    v_lshrrev_b32 v246, 2, v7
    v_and_b32 v247, 3, v7
    v_mul_lo_u32 v246, v246, s32
    v_lshl_add_u32 v246, v247, 4, v246
    s_lshl_b32 s32, s32, 7
    s_add_u32 s52, s51, s32
    s_add_u32 s53, s52, s32
    s_add_u32 s54, s53, s32
    s_branch ULX_5
ULKV_7:
    s_mov_b32 s84, s68
    s_mov_b32 s85, s69
    s_mov_b32 s86, 16384
    s_mov_b32 s87, 0x20000
    s_mov_b32 s88, s70
    s_mov_b32 s89, s71
    s_mov_b32 s90, 16384
    s_mov_b32 s91, 0x20000
    s_mov_b32 s51, 0
    s_mov_b32 s52, 0
    s_mov_b32 s53, 8192
    s_mov_b32 s54, 8192
    v_lshlrev_b32 v246, 4, v7
    s_branch ULX_5
ULD_4:
    s_mov_b32 s84, s80
    s_mov_b32 s85, s81
    s_mov_b32 s86, 1835008
    s_mov_b32 s87, 0x20000
    s_mov_b32 s88, s80
    s_mov_b32 s89, s81
    s_mov_b32 s90, 1835008
    s_mov_b32 s91, 0x20000
    s_sub_u32 s30, s55, 112
    s_and_b32 s31, s30, 7
    s_lshr_b32 s30, s30, 3
    s_mul_i32 s51, s30, 229376
    s_lshl_b32 s31, s31, 7
    s_add_u32 s51, s51, s31
    s_add_u32 s52, s51, 65536
    s_add_u32 s53, s51, 131072
    s_add_u32 s54, s51, 196608
    v_lshrrev_b32 v246, 3, v7
    v_and_b32 v247, 7, v7
    v_lshlrev_b32 v246, 10, v246
    v_lshl_add_u32 v246, v247, 4, v246
ULX_5:
    s_cmp_eq_u32 s20, 0
    s_cbranch_scc1 NOU0_9
    buffer_load_dwordx4 v[72:75], v246, s[84:87], s51 offen
    buffer_load_dwordx4 v[76:79], v246, s[88:91], s52 offen
    buffer_load_dwordx4 v[80:83], v246, s[84:87], s53 offen
    buffer_load_dwordx4 v[84:87], v246, s[88:91], s54 offen
NOU0_9:
    s_mov_b32 s8, s4
    s_mov_b32 s9, s5
    s_mov_b32 s10, 268435456
    s_mov_b32 s11, 0x20000
    s_mov_b32 s12, s6
    s_mov_b32 s13, s7
    s_mov_b32 s14, 2097152
    s_mov_b32 s15, 0x20000
    s_mov_b32 s60, s82
    s_mov_b32 s61, s83
    s_mov_b32 s62, 256
    s_mov_b32 s63, 0x20000
    s_cmp_eq_u32 s3, 5
    s_cselect_b32 s45, 1, 0
    s_cmp_eq_u32 s20, 0
    s_cselect_b32 s45, s45, 0
    s_cmp_eq_u32 s45, 0
    s_cbranch_scc1 NOCLR_10
    s_lshl_b32 s30, s19, 8
    s_add_u32 s30, s30, 7421952
    v_add_u32 v8, s30, v1
    s_lshl_b32 s30, s19, 7
    s_add_u32 s30, s30, 7405312
    v_add_u32 v9, s30, v1
    v_cmp_le_u32 vcc, 16, v0
    s_lshl_b32 s30, s19, 4
    s_add_u32 s30, s30, 7413760
    v_cndmask_b32 v8, v8, v9, vcc
    v_mov_b32 v9, s30
    v_cmp_le_u32 vcc, 24, v0
    v_mov_b32 v12, 0
    v_mov_b32 v13, 0
    v_mov_b32 v14, 0
    v_mov_b32 v15, 0
    v_cndmask_b32 v8, v8, v9, vcc
    buffer_store_dwordx4 v[12:15], v8, s[8:11], 0 offen sc1
NOCLR_10:
    s_mov_b32 s17, 0
    s_mov_b32 s18, 0
    s_lshr_b32 s21, s16, 3
    s_and_b32 s22, s16, 7
    s_and_b32 s23, s16, 31
    s_lshr_b32 s24, s16, 5
    s_lshl_b32 s25, s16, 3
    s_add_u32 s25, s25, s3
    s_lshl_b32 s25, s25, 2
    s_add_u32 s25, s25, 7405568
    s_mov_b32 s26, 0
    s_mov_b32 s27, 0x3f803f80
    s_mov_b32 s28, 0xffff
    s_mov_b32 s29, 0xffff
    s_cmp_lt_u32 s3, 4
    s_cselect_b32 s48, 1, 0
    s_cmp_eq_u32 s20, 0
    s_cselect_b32 s48, s48, 0
    s_mov_b32 s49, 6619136
    s_getreg_b32 s50, hwreg(HW_REG_XCC_ID)
    s_and_b32 s50, s50, 15
    s_add_u32 s50, s50, 1
    v_lshrrev_b32 v244, 4, v0
    v_bfe_u32 v245, v0, 2, 2
    v_xor_b32 v245, v245, v244
    v_lshlrev_b32 v245, 6, v245
    v_lshl_add_u32 v245, v244, 10, v245
    v_and_b32 v244, 3, v0
    v_lshl_add_u32 v244, v244, 4, v245
    s_and_b32 s36, s3, 2
    s_lshl_b32 s36, s36, 4
    v_xor_b32 v244, s36, v244
    s_lshl_b32 s36, s3, 10
    s_lshl_b32 s37, s3, 12
    s_lshl_b32 s38, s20, 8
    s_add_u32 s37, s37, s38
    s_waitcnt vmcnt(8)
    s_cmp_eq_u32 s20, 0
    s_cbranch_scc0 U0J_11
    s_waitcnt vmcnt(0)
    s_cmp_eq_u32 s45, 0
    s_cbranch_scc1 U0J_11
    s_lshl_b32 s30, s19, 2
    v_mov_b32 v8, s30
    v_mov_b32 v9, 1
    s_mov_b64 exec, 1
    buffer_store_dword v9, v8, s[60:63], 0 offen sc1
    s_mov_b64 exec, -1
U0J_11:
    s_lshl_b32 s30, s3, 11
    v_add_u32 v2, s30, v1
    ds_read_b128 v[8:11], v2 offset:0
    ds_read_b128 v[12:15], v2 offset:1024
    ds_read_b128 v[16:19], v2 offset:16384
    ds_read_b128 v[20:23], v2 offset:17408
    v_and_b32 v3, 31, v0
    v_lshrrev_b32 v4, 5, v0
    v_lshlrev_b32 v4, 2, v4
    v_lshl_add_u32 v3, v3, 3, v4
    s_lshl_b32 s30, s3, 9
    s_add_u32 s30, s30, 98304
    v_add_u32 v3, s30, v3
    v_mov_b32 v240, s27
    v_mov_b32 v241, s27
    v_mov_b32 v242, s27
    v_mov_b32 v243, s27
    v_mov_b32 v6, 0
    v_mov_b32 v5, 102400
    ds_write_b32 v3, v6 offset:256
    ds_write_b32 v5, v6
    s_waitcnt lgkmcnt(2)
    v_dot2_f32_bf16 v216, v8, s27, 0
    v_dot2_f32_bf16 v217, v8, v8, 0
    v_dot2_f32_bf16 v218, v16, s27, 0
    v_dot2_f32_bf16 v219, v16, v16, 0
    v_dot2_f32_bf16 v216, v9, s27, v216
    v_dot2_f32_bf16 v217, v9, v9, v217
    v_dot2_f32_bf16 v218, v17, s27, v218
    v_dot2_f32_bf16 v219, v17, v17, v219
    v_dot2_f32_bf16 v216, v10, s27, v216
    v_dot2_f32_bf16 v217, v10, v10, v217
    v_dot2_f32_bf16 v218, v18, s27, v218
    v_dot2_f32_bf16 v219, v18, v18, v219
    v_dot2_f32_bf16 v216, v11, s27, v216
    v_dot2_f32_bf16 v217, v11, v11, v217
    v_dot2_f32_bf16 v218, v19, s27, v218
    v_dot2_f32_bf16 v219, v19, v19, v219
    v_dot2_f32_bf16 v216, v12, s27, v216
    v_dot2_f32_bf16 v217, v12, v12, v217
    v_dot2_f32_bf16 v218, v20, s27, v218
    v_dot2_f32_bf16 v219, v20, v20, v219
    v_dot2_f32_bf16 v216, v13, s27, v216
    v_dot2_f32_bf16 v217, v13, v13, v217
    v_dot2_f32_bf16 v218, v21, s27, v218
    v_dot2_f32_bf16 v219, v21, v21, v219
    v_dot2_f32_bf16 v216, v14, s27, v216
    v_dot2_f32_bf16 v217, v14, v14, v217
    v_dot2_f32_bf16 v218, v22, s27, v218
    v_dot2_f32_bf16 v219, v22, v22, v219
    v_dot2_f32_bf16 v216, v15, s27, v216
    v_dot2_f32_bf16 v217, v15, v15, v217
    v_dot2_f32_bf16 v218, v23, s27, v218
    v_dot2_f32_bf16 v219, v23, v23, v219
    v_lshrrev_b32 v2, 5, v0
    v_lshlrev_b32 v2, 11, v2
    v_and_b32 v4, 31, v0
    v_permlane32_swap_b32 v216, v217
    v_permlane32_swap_b32 v218, v219
    v_add_f32 v216, v216, v217
    v_add_f32 v218, v218, v219
    v_lshl_add_u32 v2, v4, 3, v2
    v_add_u32 v2, 98304, v2
    v_permlane16_swap_b32 v216, v218
    v_add_f32 v216, v216, v218
    s_and_b32 s30, s3, 1
    s_lshl_b32 s30, s30, 14
    v_add_u32 v4, s30, v1
    ds_write_b32 v3, v216
    v_lshrrev_b32 v5, 4, v0
    v_lshlrev_b32 v5, 8, v5
    v_bfe_u32 v6, v0, 2, 2
    v_lshl_add_u32 v5, v6, 5, v5
    v_and_b32 v6, 3, v0
    v_lshl_add_u32 v5, v6, 3, v5
    s_lshr_b32 s30, s3, 1
    s_lshl_b32 s30, s30, 14
    s_add_u32 s30, s30, 131072
    v_add_u32 v236, s30, v5
    s_waitcnt lgkmcnt(0)
    s_barrier
    ds_read2_b64 v[216:219], v2 offset0:0 offset1:32
    ds_read2_b64 v[220:223], v2 offset0:64 offset1:96
    ds_read2_b64 v[224:227], v2 offset0:128 offset1:160
    ds_read2_b64 v[228:231], v2 offset0:192 offset1:224
    s_cmp_eq_u32 s48, 0
    s_cbranch_scc1 NOKVRD_12
    s_setprio 2
    ds_read_b128 v[8:11], v4 offset:0
    ds_read_b64_tr_b16 v[72:73], v236 offset:0
    ds_read_b64_tr_b16 v[74:75], v236 offset:128
    ds_read_b128 v[12:15], v4 offset:1024
    ds_read_b64_tr_b16 v[76:77], v236 offset:1024
    ds_read_b64_tr_b16 v[78:79], v236 offset:1152
    ds_read_b128 v[16:19], v4 offset:2048
    ds_read_b64_tr_b16 v[80:81], v236 offset:2048
    ds_read_b64_tr_b16 v[82:83], v236 offset:2176
    s_waitcnt lgkmcnt(9)
    ds_read_b128 v[20:23], v4 offset:3072
    ds_read_b64_tr_b16 v[84:85], v236 offset:3072
    ds_read_b64_tr_b16 v[86:87], v236 offset:3200
    ds_read_b128 v[24:27], v4 offset:4096
    ds_read_b64_tr_b16 v[88:89], v236 offset:4096
    ds_read_b64_tr_b16 v[90:91], v236 offset:4224
    ds_read_b128 v[28:31], v4 offset:5120
    ds_read_b64_tr_b16 v[92:93], v236 offset:5120
    ds_read_b64_tr_b16 v[94:95], v236 offset:5248
    ds_read_b128 v[32:35], v4 offset:6144
    ds_read_b64_tr_b16 v[96:97], v236 offset:6144
    ds_read_b64_tr_b16 v[98:99], v236 offset:6272
    ds_read_b128 v[36:39], v4 offset:7168
    ds_read_b64_tr_b16 v[100:101], v236 offset:7168
    ds_read_b64_tr_b16 v[102:103], v236 offset:7296
    s_branch KVRD_13
NOKVRD_12:
    s_waitcnt lgkmcnt(0)
KVRD_13:
    v_pk_add_f32 v[216:217], v[216:217], v[218:219]
    v_pk_add_f32 v[220:221], v[220:221], v[222:223]
    v_pk_add_f32 v[224:225], v[224:225], v[226:227]
    v_pk_add_f32 v[228:229], v[228:229], v[230:231]
    v_pk_add_f32 v[216:217], v[216:217], v[220:221]
    v_pk_add_f32 v[224:225], v[224:225], v[228:229]
    v_pk_add_f32 v[216:217], v[216:217], v[224:225]
    v_mov_b32 v218, v216
    v_mov_b32 v219, v217
    s_nop 1
    v_permlane32_swap_b32 v216, v218
    v_permlane32_swap_b32 v217, v219
    v_add_f32 v216, v216, v218
    v_add_f32 v217, v217, v219
    v_mul_f32 v216, 0x3b000000, v216
    v_mul_f32 v217, 0x3b000000, v217
    v_fma_f32 v217, -v216, v216, v217
    v_max_f32 v217, 0, v217
    v_add_f32 v217, 925353388, v217
    v_rsq_f32 v232, v217
    v_mov_b32 v234, v216
    v_mov_b32 v235, v216
    v_mov_b32 v233, v232
    s_nop 1
    v_permlane16_swap_b32 v232, v233
    v_permlane16_swap_b32 v234, v235
    s_cmp_eq_u32 s48, 0
    s_cbranch_scc1 NOKV_14
    s_bitcmp1_b32 s3, 0
    s_cselect_b64 vcc, -1, 0
    v_cndmask_b32 v216, v232, v233, vcc
    v_cndmask_b32 v217, v234, v235, vcc
    v_and_b32 v5, 15, v0
    v_lshrrev_b32 v6, 4, v0
    v_lshrrev_b32 v7, 5, v0
    v_lshlrev_b32 v7, 9, v7
    v_lshl_add_u32 v7, v5, 4, v7
    v_and_b32 v5, 1, v6
    v_lshl_add_u32 v7, v5, 3, v7
    s_lshl_b32 s31, s19, 11
    s_add_u32 s31, s31, s49
    s_and_b32 s30, s3, 1
    s_lshl_b32 s30, s30, 8
    s_add_u32 s31, s31, s30
    s_cmp_ge_u32 s3, 2
    s_cbranch_scc1 ISV_15
    s_waitcnt lgkmcnt(0)
    ds_read_b128 v[40:43], v4 offset:8192
    ds_read_b64_tr_b16 v[104:105], v236 offset:8192
    ds_read_b64_tr_b16 v[106:107], v236 offset:8320
    v_mfma_f32_16x16x32_bf16 v[208:211], v[72:75], v[8:11], 0
    v_mfma_f32_16x16x32_bf16 v[204:207], v[72:75], v[240:243], 0
    ds_read_b128 v[44:47], v4 offset:9216
    ds_read_b64_tr_b16 v[108:109], v236 offset:9216
    ds_read_b64_tr_b16 v[110:111], v236 offset:9344
    v_mfma_f32_16x16x32_bf16 v[208:211], v[76:79], v[12:15], v[208:211]
    v_mfma_f32_16x16x32_bf16 v[204:207], v[76:79], v[240:243], v[204:207]
    ds_read_b128 v[48:51], v4 offset:10240
    ds_read_b64_tr_b16 v[112:113], v236 offset:10240
    ds_read_b64_tr_b16 v[114:115], v236 offset:10368
    v_mfma_f32_16x16x32_bf16 v[208:211], v[80:83], v[16:19], v[208:211]
    v_mfma_f32_16x16x32_bf16 v[204:207], v[80:83], v[240:243], v[204:207]
    ds_read_b128 v[52:55], v4 offset:11264
    ds_read_b64_tr_b16 v[116:117], v236 offset:11264
    ds_read_b64_tr_b16 v[118:119], v236 offset:11392
    v_mfma_f32_16x16x32_bf16 v[208:211], v[84:87], v[20:23], v[208:211]
    v_mfma_f32_16x16x32_bf16 v[204:207], v[84:87], v[240:243], v[204:207]
    ds_read_b128 v[56:59], v4 offset:12288
    ds_read_b64_tr_b16 v[120:121], v236 offset:12288
    ds_read_b64_tr_b16 v[122:123], v236 offset:12416
    v_mfma_f32_16x16x32_bf16 v[208:211], v[88:91], v[24:27], v[208:211]
    v_mfma_f32_16x16x32_bf16 v[204:207], v[88:91], v[240:243], v[204:207]
    ds_read_b128 v[60:63], v4 offset:13312
    ds_read_b64_tr_b16 v[124:125], v236 offset:13312
    ds_read_b64_tr_b16 v[126:127], v236 offset:13440
    v_mfma_f32_16x16x32_bf16 v[208:211], v[92:95], v[28:31], v[208:211]
    v_mfma_f32_16x16x32_bf16 v[204:207], v[92:95], v[240:243], v[204:207]
    ds_read_b128 v[64:67], v4 offset:14336
    ds_read_b64_tr_b16 v[128:129], v236 offset:14336
    ds_read_b64_tr_b16 v[130:131], v236 offset:14464
    v_mfma_f32_16x16x32_bf16 v[208:211], v[96:99], v[32:35], v[208:211]
    v_mfma_f32_16x16x32_bf16 v[204:207], v[96:99], v[240:243], v[204:207]
    ds_read_b128 v[68:71], v4 offset:15360
    ds_read_b64_tr_b16 v[132:133], v236 offset:15360
    ds_read_b64_tr_b16 v[134:135], v236 offset:15488
    v_mfma_f32_16x16x32_bf16 v[208:211], v[100:103], v[36:39], v[208:211]
    v_mfma_f32_16x16x32_bf16 v[204:207], v[100:103], v[240:243], v[204:207]
    s_waitcnt lgkmcnt(15)
    v_mfma_f32_16x16x32_bf16 v[208:211], v[104:107], v[40:43], v[208:211]
    v_mfma_f32_16x16x32_bf16 v[204:207], v[104:107], v[240:243], v[204:207]
    s_waitcnt lgkmcnt(15)
    v_mfma_f32_16x16x32_bf16 v[208:211], v[108:111], v[44:47], v[208:211]
    v_mfma_f32_16x16x32_bf16 v[204:207], v[108:111], v[240:243], v[204:207]
    s_waitcnt lgkmcnt(15)
    v_mfma_f32_16x16x32_bf16 v[208:211], v[112:115], v[48:51], v[208:211]
    v_mfma_f32_16x16x32_bf16 v[204:207], v[112:115], v[240:243], v[204:207]
    s_waitcnt lgkmcnt(12)
    v_mfma_f32_16x16x32_bf16 v[208:211], v[116:119], v[52:55], v[208:211]
    v_mfma_f32_16x16x32_bf16 v[204:207], v[116:119], v[240:243], v[204:207]
    s_waitcnt lgkmcnt(9)
    v_mfma_f32_16x16x32_bf16 v[208:211], v[120:123], v[56:59], v[208:211]
    v_mfma_f32_16x16x32_bf16 v[204:207], v[120:123], v[240:243], v[204:207]
    s_waitcnt lgkmcnt(6)
    v_mfma_f32_16x16x32_bf16 v[208:211], v[124:127], v[60:63], v[208:211]
    v_mfma_f32_16x16x32_bf16 v[204:207], v[124:127], v[240:243], v[204:207]
    s_waitcnt lgkmcnt(3)
    v_mfma_f32_16x16x32_bf16 v[208:211], v[128:131], v[64:67], v[208:211]
    v_mfma_f32_16x16x32_bf16 v[204:207], v[128:131], v[240:243], v[204:207]
    s_waitcnt lgkmcnt(0)
    v_mfma_f32_16x16x32_bf16 v[208:211], v[132:135], v[68:71], v[208:211]
    v_mfma_f32_16x16x32_bf16 v[204:207], v[132:135], v[240:243], v[204:207]
    s_nop 7
    v_fma_f32 v208, -v217, v204, v208
    v_fma_f32 v209, -v217, v205, v209
    v_fma_f32 v210, -v217, v206, v210
    v_fma_f32 v211, -v217, v207, v211
    v_mul_f32 v208, v208, v216
    v_mul_f32 v209, v209, v216
    v_mul_f32 v210, v210, v216
    v_mul_f32 v211, v211, v216
    s_branch KVST_16
ISV_15:
    v_lshlrev_b32 v5, 4, v6
    ds_bpermute_b32 v220, v5, v216 offset:0
    ds_bpermute_b32 v224, v5, v217 offset:0
    ds_bpermute_b32 v221, v5, v216 offset:4
    ds_bpermute_b32 v225, v5, v217 offset:4
    ds_bpermute_b32 v222, v5, v216 offset:8
    ds_bpermute_b32 v226, v5, v217 offset:8
    ds_bpermute_b32 v223, v5, v216 offset:12
    ds_bpermute_b32 v227, v5, v217 offset:12
    s_add_u32 s31, s31, 1024
    s_waitcnt lgkmcnt(0)
    ds_read_b128 v[40:43], v4 offset:8192
    ds_read_b64_tr_b16 v[104:105], v236 offset:8192
    ds_read_b64_tr_b16 v[106:107], v236 offset:8320
    v_mfma_f32_16x16x32_bf16 v[208:211], v[8:11], v[72:75], 0
    v_mfma_f32_16x16x32_bf16 v[204:207], v[240:243], v[72:75], 0
    ds_read_b128 v[44:47], v4 offset:9216
    ds_read_b64_tr_b16 v[108:109], v236 offset:9216
    ds_read_b64_tr_b16 v[110:111], v236 offset:9344
    v_mfma_f32_16x16x32_bf16 v[208:211], v[12:15], v[76:79], v[208:211]
    v_mfma_f32_16x16x32_bf16 v[204:207], v[240:243], v[76:79], v[204:207]
    ds_read_b128 v[48:51], v4 offset:10240
    ds_read_b64_tr_b16 v[112:113], v236 offset:10240
    ds_read_b64_tr_b16 v[114:115], v236 offset:10368
    v_mfma_f32_16x16x32_bf16 v[208:211], v[16:19], v[80:83], v[208:211]
    v_mfma_f32_16x16x32_bf16 v[204:207], v[240:243], v[80:83], v[204:207]
    ds_read_b128 v[52:55], v4 offset:11264
    ds_read_b64_tr_b16 v[116:117], v236 offset:11264
    ds_read_b64_tr_b16 v[118:119], v236 offset:11392
    v_mfma_f32_16x16x32_bf16 v[208:211], v[20:23], v[84:87], v[208:211]
    v_mfma_f32_16x16x32_bf16 v[204:207], v[240:243], v[84:87], v[204:207]
    ds_read_b128 v[56:59], v4 offset:12288
    ds_read_b64_tr_b16 v[120:121], v236 offset:12288
    ds_read_b64_tr_b16 v[122:123], v236 offset:12416
    v_mfma_f32_16x16x32_bf16 v[208:211], v[24:27], v[88:91], v[208:211]
    v_mfma_f32_16x16x32_bf16 v[204:207], v[240:243], v[88:91], v[204:207]
    ds_read_b128 v[60:63], v4 offset:13312
    ds_read_b64_tr_b16 v[124:125], v236 offset:13312
    ds_read_b64_tr_b16 v[126:127], v236 offset:13440
    v_mfma_f32_16x16x32_bf16 v[208:211], v[28:31], v[92:95], v[208:211]
    v_mfma_f32_16x16x32_bf16 v[204:207], v[240:243], v[92:95], v[204:207]
    ds_read_b128 v[64:67], v4 offset:14336
    ds_read_b64_tr_b16 v[128:129], v236 offset:14336
    ds_read_b64_tr_b16 v[130:131], v236 offset:14464
    v_mfma_f32_16x16x32_bf16 v[208:211], v[32:35], v[96:99], v[208:211]
    v_mfma_f32_16x16x32_bf16 v[204:207], v[240:243], v[96:99], v[204:207]
    ds_read_b128 v[68:71], v4 offset:15360
    ds_read_b64_tr_b16 v[132:133], v236 offset:15360
    ds_read_b64_tr_b16 v[134:135], v236 offset:15488
    v_mfma_f32_16x16x32_bf16 v[208:211], v[36:39], v[100:103], v[208:211]
    v_mfma_f32_16x16x32_bf16 v[204:207], v[240:243], v[100:103], v[204:207]
    s_waitcnt lgkmcnt(15)
    v_mfma_f32_16x16x32_bf16 v[208:211], v[40:43], v[104:107], v[208:211]
    v_mfma_f32_16x16x32_bf16 v[204:207], v[240:243], v[104:107], v[204:207]
    s_waitcnt lgkmcnt(15)
    v_mfma_f32_16x16x32_bf16 v[208:211], v[44:47], v[108:111], v[208:211]
    v_mfma_f32_16x16x32_bf16 v[204:207], v[240:243], v[108:111], v[204:207]
    s_waitcnt lgkmcnt(15)
    v_mfma_f32_16x16x32_bf16 v[208:211], v[48:51], v[112:115], v[208:211]
    v_mfma_f32_16x16x32_bf16 v[204:207], v[240:243], v[112:115], v[204:207]
    s_waitcnt lgkmcnt(12)
    v_mfma_f32_16x16x32_bf16 v[208:211], v[52:55], v[116:119], v[208:211]
    v_mfma_f32_16x16x32_bf16 v[204:207], v[240:243], v[116:119], v[204:207]
    s_waitcnt lgkmcnt(9)
    v_mfma_f32_16x16x32_bf16 v[208:211], v[56:59], v[120:123], v[208:211]
    v_mfma_f32_16x16x32_bf16 v[204:207], v[240:243], v[120:123], v[204:207]
    s_waitcnt lgkmcnt(6)
    v_mfma_f32_16x16x32_bf16 v[208:211], v[60:63], v[124:127], v[208:211]
    v_mfma_f32_16x16x32_bf16 v[204:207], v[240:243], v[124:127], v[204:207]
    s_waitcnt lgkmcnt(3)
    v_mfma_f32_16x16x32_bf16 v[208:211], v[64:67], v[128:131], v[208:211]
    v_mfma_f32_16x16x32_bf16 v[204:207], v[240:243], v[128:131], v[204:207]
    s_waitcnt lgkmcnt(0)
    v_mfma_f32_16x16x32_bf16 v[208:211], v[68:71], v[132:135], v[208:211]
    v_mfma_f32_16x16x32_bf16 v[204:207], v[240:243], v[132:135], v[204:207]
    s_waitcnt lgkmcnt(0)
    s_nop 6
    v_fma_f32 v208, -v224, v204, v208
    v_fma_f32 v209, -v225, v205, v209
    v_fma_f32 v210, -v226, v206, v210
    v_fma_f32 v211, -v227, v207, v211
    v_mul_f32 v208, v208, v220
    v_mul_f32 v209, v209, v221
    v_mul_f32 v210, v210, v222
    v_mul_f32 v211, v211, v223
KVST_16:
    v_cvt_pk_bf16_f32 v212, v208, v209
    v_cvt_pk_bf16_f32 v213, v210, v211
    buffer_store_dwordx2 v[212:213], v7, s[8:11], s31 offen sc1
    s_setprio 0
NOKV_14:
    s_cmp_eq_u32 s48, 0
    s_cbranch_scc1 NOKVF_17
    s_lshl_b32 s30, s19, 8
    s_add_u32 s30, s30, 7421952
    s_add_u32 s31, s17, 1
    v_mov_b32 v4, s31
    v_mov_b32 v3, s30
    v_mov_b32 v5, 102400
    v_mov_b32 v6, 1
    s_mov_b64 exec, 1
    s_waitcnt vmcnt(0)
    ds_add_rtn_u32 v6, v5, v6
    s_waitcnt lgkmcnt(0)
    v_cmp_eq_u32 vcc, 3, v6
    s_nop 0
    s_and_b64 exec, exec, vcc
    s_cbranch_execz KVNL_18
    buffer_store_dword v4, v3, s[8:11], 0 offen sc1
KVNL_18:
    s_mov_b64 exec, -1
NOKVF_17:
    s_add_u32 m0, s36, 32768
    s_add_u32 s38, s37, 0
    buffer_load_dwordx4 v244, s[40:43], s38 offen lds
    s_add_u32 m0, s36, 40960
    s_add_u32 s38, s37, 32768
    buffer_load_dwordx4 v244, s[40:43], s38 offen lds
    s_add_u32 m0, s36, 49152
    s_add_u32 s38, s37, 65536
    buffer_load_dwordx4 v244, s[40:43], s38 offen lds
    s_add_u32 m0, s36, 57344
    s_add_u32 s38, s37, 98304
    buffer_load_dwordx4 v244, s[40:43], s38 offen lds
    s_add_u32 m0, s36, 65536
    s_add_u32 s38, s37, 131072
    buffer_load_dwordx4 v244, s[40:43], s38 offen lds
    s_add_u32 m0, s36, 73728
    s_add_u32 s38, s37, 163840
    buffer_load_dwordx4 v244, s[40:43], s38 offen lds
    s_add_u32 m0, s36, 81920
    s_add_u32 s38, s37, 196608
    buffer_load_dwordx4 v244, s[40:43], s38 offen lds
    s_add_u32 m0, s36, 90112
    s_add_u32 s38, s37, 229376
    buffer_load_dwordx4 v244, s[40:43], s38 offen lds
    s_cmp_eq_u32 s20, 0
    s_cbranch_scc0 KVWQ_19
    buffer_load_dwordx4 v[72:75], v246, s[84:87], s51 offen
    buffer_load_dwordx4 v[76:79], v246, s[88:91], s52 offen
    buffer_load_dwordx4 v[80:83], v246, s[84:87], s53 offen
    buffer_load_dwordx4 v[84:87], v246, s[88:91], s54 offen
    s_barrier
KVWQ_19:
    v_lshlrev_b32 v248, 8, v0
    v_add_u32 v248, 7421952, v248
    s_add_u32 s47, s17, 1
    v_lshlrev_b32 v249, 2, v0
    s_cmp_eq_u32 s3, 7
    s_cbranch_scc0 NOW7_20
    buffer_load_dword v250, v249, s[60:63], 0 offen sc1
NOW7_20:
    v_mov_b32 v66, v1
    s_cmp_ge_u32 s55, 209
    s_cbranch_scc1 UNONE_26
    s_lshl_b32 s96, s3, 6
    v_add_u32 v65, s96, v0
    v_and_b32 v61, 15, v0
    v_lshrrev_b32 v62, 4, v0
    s_and_b32 s98, s3, 1
    s_lshr_b32 s99, s3, 1
    s_cmp_ge_u32 s55, 192
    s_cbranch_scc1 UQ_24
    s_cmp_ge_u32 s55, 176
    s_cbranch_scc1 UO_25
    s_cmp_ge_u32 s55, 112
    s_cbranch_scc1 UD_22
    s_lshr_b32 s96, s55, 1
    s_lshl_b32 s96, s96, 1
    s_add_u32 s96, s96, s98
    s_lshl_b32 s96, s96, 1
    s_mul_i32 s97, s96, 9363
    s_lshr_b32 s97, s97, 16
    s_mul_i32 s46, s97, 7
    s_sub_u32 s46, s96, s46
    s_mul_i32 s51, s97, 114688
    s_lshl_b32 s46, s46, 10
    s_add_u32 s51, s51, s46
    s_add_u32 s96, s96, 1
    s_mul_i32 s97, s96, 9363
    s_lshr_b32 s97, s97, 16
    s_mul_i32 s46, s97, 7
    s_sub_u32 s46, s96, s46
    s_mul_i32 s52, s97, 114688
    s_lshl_b32 s46, s46, 10
    s_add_u32 s52, s52, s46
    s_sub_u32 s52, s52, s51
    v_lshrrev_b32 v60, 3, v61
    v_mul_lo_u32 v66, v60, s52
    s_and_b32 s46, s55, 1
    s_lshl_b32 s97, s46, 3
    v_and_b32 v60, 7, v61
    v_lshl_add_u32 v60, v62, 3, v60
    v_add_u32 v60, s97, v60
    v_and_b32 v60, 31, v60
    v_lshl_add_u32 v66, v60, 4, v66
    s_lshl_b32 s46, s46, 9
    s_add_u32 s51, s51, s46
    s_mul_i32 s46, s99, 28672
    s_add_u32 s51, s51, s46
    s_add_u32 s51, s51, 1114112
    s_mov_b32 s52, 7168
    s_branch UQQ_27
UO_25:
    s_sub_u32 s96, s55, 176
    s_lshl_b32 s96, s96, 1
    s_add_u32 s96, s96, s98
    s_lshl_b32 s51, s96, 14
    s_lshl_b32 s46, s99, 12
    s_add_u32 s51, s51, s46
    s_add_u32 s51, s51, 589824
    s_mov_b32 s52, 1024
    s_mov_b32 s54, 8
    v_lshlrev_b32 v63, 1, v61
    s_lshl_b32 s46, s98, 5
    v_add_u32 v63, s46, v63
    v_and_b32 v60, 1, v62
    v_lshlrev_b32 v64, 4, v60
    v_lshrrev_b32 v60, 1, v62
    v_lshl_add_u32 v64, v60, 2, v64
    s_branch UC_23
UQ_24:
    s_sub_u32 s96, s55, 192
    s_lshl_b32 s96, s96, 1
    s_add_u32 s96, s96, s98
    s_lshl_b32 s51, s96, 14
    s_lshl_b32 s46, s99, 12
    s_add_u32 s51, s51, s46
    s_mov_b32 s52, 1024
UQQ_27:
    s_mov_b32 s54, 4
    v_lshlrev_b32 v63, 1, v61
    s_lshl_b32 s46, s98, 5
    v_add_u32 v63, s46, v63
    v_lshlrev_b32 v64, 3, v62
UC_23:
    s_cmp_eq_u32 s55, 208
    s_cselect_b32 s46, 1, 2
    s_cselect_b32 s96, 1, 3
    v_lshrrev_b32 v60, s46, v65
    v_and_b32 v65, s96, v65
    v_mul_u32_u24 v60, 72, v60
    v_lshl_add_u32 v60, v65, 4, v60
    v_add_u32 v56, 122880, v60
    s_cselect_b32 s46, 32, 9216
    v_add_u32 v57, s46, v56
    v_add_u32 v58, 18432, v56
    v_add_u32 v59, 18432, v57
    s_lshl_b32 s46, s99, 7
    v_add_u32 v64, s46, v64
    v_mul_u32_u24 v64, 72, v64
    v_add_u32 v63, v63, v64
    v_add_u32 v63, 122880, v63
    s_mul_i32 s46, s54, 72
    v_add_u32 v64, s46, v63
    s_mov_b32 s53, 0xffff0000
    v_mov_b32 v8, 0
    v_mov_b32 v9, 0
    v_mov_b32 v10, 0
    v_mov_b32 v11, 0
    v_mov_b32 v12, 0
    v_mov_b32 v13, 0
    v_mov_b32 v14, 0
    v_mov_b32 v15, 0
    v_mov_b32 v16, 0
    v_mov_b32 v17, 0
    v_mov_b32 v18, 0
    v_mov_b32 v19, 0
    v_mov_b32 v20, 0
    v_mov_b32 v21, 0
    v_mov_b32 v22, 0
    v_mov_b32 v23, 0
    v_mov_b32 v24, 0
    v_mov_b32 v25, 0
    v_mov_b32 v26, 0
    v_mov_b32 v27, 0
    v_mov_b32 v28, 0
    v_mov_b32 v29, 0
    v_mov_b32 v30, 0
    v_mov_b32 v31, 0
    v_mov_b32 v32, 0
    v_mov_b32 v33, 0
    v_mov_b32 v34, 0
    v_mov_b32 v35, 0
    v_mov_b32 v36, 0
    v_mov_b32 v37, 0
    v_mov_b32 v38, 0
    v_mov_b32 v39, 0
    s_lshl_b32 s46, s3, 6
    s_add_u32 s46, s46, 159744
    v_lshl_add_u32 v60, v61, 2, s46
    s_waitcnt vmcnt(8)
    s_cmp_eq_u32 s20, 0
    s_cbranch_scc0 UW_28
    s_waitcnt vmcnt(0)
UW_28:
    ds_write2_b64 v56, v[72:73], v[74:75] offset0:0 offset1:1
    ds_write2_b64 v57, v[76:77], v[78:79] offset0:0 offset1:1
    ds_write2_b64 v58, v[80:81], v[82:83] offset0:0 offset1:1
    ds_write2_b64 v59, v[84:85], v[86:87] offset0:0 offset1:1
    s_waitcnt lgkmcnt(0)
    s_barrier
    s_cmp_ge_u32 s55, 112
    s_cbranch_scc1 UPL_30
    ds_read_u16_d16_hi v8, v63 offset:0
    ds_read_u16_d16_hi v9, v63 offset:72
    ds_read_u16_d16_hi v10, v63 offset:144
    ds_read_u16_d16_hi v11, v63 offset:216
    ds_read_u16_d16_hi v12, v64 offset:0
    ds_read_u16_d16_hi v13, v64 offset:72
    ds_read_u16_d16_hi v14, v64 offset:144
    ds_read_u16_d16_hi v15, v64 offset:216
    s_add_u32 m0, s36, 98304
    s_add_u32 s38, s37, 262144
    buffer_load_dwordx4 v244, s[40:43], s38 offen lds
    ds_read_u16_d16_hi v16, v63 offset:2304
    ds_read_u16_d16_hi v17, v63 offset:2376
    ds_read_u16_d16_hi v18, v63 offset:2448
    ds_read_u16_d16_hi v19, v63 offset:2520
    ds_read_u16_d16_hi v20, v64 offset:2304
    ds_read_u16_d16_hi v21, v64 offset:2376
    ds_read_u16_d16_hi v22, v64 offset:2448
    ds_read_u16_d16_hi v23, v64 offset:2520
    s_add_u32 m0, s36, 106496
    s_add_u32 s38, s37, 294912
    buffer_load_dwordx4 v244, s[40:43], s38 offen lds
    ds_read_u16_d16_hi v24, v63 offset:4608
    ds_read_u16_d16_hi v25, v63 offset:4680
    ds_read_u16_d16_hi v26, v63 offset:4752
    ds_read_u16_d16_hi v27, v63 offset:4824
    ds_read_u16_d16_hi v28, v64 offset:4608
    ds_read_u16_d16_hi v29, v64 offset:4680
    ds_read_u16_d16_hi v30, v64 offset:4752
    ds_read_u16_d16_hi v31, v64 offset:4824
    s_add_u32 m0, s36, 114688
    s_add_u32 s38, s37, 327680
    buffer_load_dwordx4 v244, s[40:43], s38 offen lds
    ds_read_u16_d16_hi v32, v63 offset:6912
    ds_read_u16_d16_hi v33, v63 offset:6984
    ds_read_u16_d16_hi v34, v63 offset:7056
    ds_read_u16_d16_hi v35, v63 offset:7128
    ds_read_u16_d16_hi v36, v64 offset:6912
    ds_read_u16_d16_hi v37, v64 offset:6984
    ds_read_u16_d16_hi v38, v64 offset:7056
    ds_read_u16_d16_hi v39, v64 offset:7128
    s_lshl_b32 s46, s3, 6
    s_add_u32 s46, s46, 122880
    v_lshl_add_u32 v60, v61, 2, s46
    s_lshl_b32 s46, s98, 6
    s_add_u32 s46, s46, 122880
    v_lshl_add_u32 v65, v61, 2, s46
    s_waitcnt lgkmcnt(0)
    v_pk_add_f32 v[40:41], v[8:9], v[10:11]
    v_pk_add_f32 v[42:43], v[12:13], v[14:15]
    v_pk_add_f32 v[44:45], v[16:17], v[18:19]
    v_pk_add_f32 v[46:47], v[20:21], v[22:23]
    v_pk_add_f32 v[40:41], v[40:41], v[24:25]
    v_pk_add_f32 v[40:41], v[40:41], v[26:27]
    v_pk_add_f32 v[42:43], v[42:43], v[28:29]
    v_pk_add_f32 v[42:43], v[42:43], v[30:31]
    v_pk_add_f32 v[44:45], v[44:45], v[32:33]
    v_pk_add_f32 v[44:45], v[44:45], v[34:35]
    v_pk_add_f32 v[46:47], v[46:47], v[36:37]
    v_pk_add_f32 v[46:47], v[46:47], v[38:39]
    v_pk_add_f32 v[40:41], v[40:41], v[42:43]
    v_pk_add_f32 v[44:45], v[44:45], v[46:47]
    v_pk_add_f32 v[40:41], v[40:41], v[44:45]
    v_add_f32 v40, v40, v41
    v_mov_b32 v41, v40
    s_nop 1
    v_permlane32_swap_b32 v40, v41
    v_add_f32 v40, v40, v41
    v_mov_b32 v41, v40
    s_nop 1
    v_permlane16_swap_b32 v40, v41
    v_add_f32 v40, v40, v41
    s_barrier
    ds_write_b32 v60, v40
    s_waitcnt lgkmcnt(0)
    s_barrier
    ds_read_b32 v40, v65 offset:0
    ds_read_b32 v41, v65 offset:128
    ds_read_b32 v42, v65 offset:256
    ds_read_b32 v43, v65 offset:384
    s_waitcnt lgkmcnt(0)
    v_pk_add_f32 v[40:41], v[40:41], v[42:43]
    v_add_f32 v40, v40, v41
    v_mul_f32 v40, 0xbb000000, v40
    v_mov_b32 v41, v40
    v_pk_add_f32 v[8:9], v[8:9], v[40:41]
    v_pk_add_f32 v[10:11], v[10:11], v[40:41]
    v_pk_add_f32 v[12:13], v[12:13], v[40:41]
    v_pk_add_f32 v[14:15], v[14:15], v[40:41]
    v_pk_add_f32 v[16:17], v[16:17], v[40:41]
    v_pk_add_f32 v[18:19], v[18:19], v[40:41]
    v_pk_add_f32 v[20:21], v[20:21], v[40:41]
    v_pk_add_f32 v[22:23], v[22:23], v[40:41]
    v_pk_add_f32 v[24:25], v[24:25], v[40:41]
    v_pk_add_f32 v[26:27], v[26:27], v[40:41]
    v_pk_add_f32 v[28:29], v[28:29], v[40:41]
    v_pk_add_f32 v[30:31], v[30:31], v[40:41]
    v_pk_add_f32 v[32:33], v[32:33], v[40:41]
    v_pk_add_f32 v[34:35], v[34:35], v[40:41]
    v_pk_add_f32 v[36:37], v[36:37], v[40:41]
    v_pk_add_f32 v[38:39], v[38:39], v[40:41]
    v_cvt_pk_bf16_f32 v72, v8, v9
    v_lshlrev_b32 v42, 16, v72
    v_and_b32 v43, s53, v72
    v_pk_add_f32 v[40:41], v[8:9], v[42:43] neg_lo:[0,1] neg_hi:[0,1]
    v_pk_add_f32 v[10:11], v[10:11], v[40:41]
    v_cvt_pk_bf16_f32 v73, v10, v11
    v_lshlrev_b32 v42, 16, v73
    v_and_b32 v43, s53, v73
    v_pk_add_f32 v[40:41], v[10:11], v[42:43] neg_lo:[0,1] neg_hi:[0,1]
    v_pk_add_f32 v[12:13], v[12:13], v[40:41]
    v_cvt_pk_bf16_f32 v74, v12, v13
    v_lshlrev_b32 v42, 16, v74
    v_and_b32 v43, s53, v74
    v_pk_add_f32 v[40:41], v[12:13], v[42:43] neg_lo:[0,1] neg_hi:[0,1]
    v_pk_add_f32 v[14:15], v[14:15], v[40:41]
    v_cvt_pk_bf16_f32 v75, v14, v15
    v_lshlrev_b32 v42, 16, v75
    v_and_b32 v43, s53, v75
    v_pk_add_f32 v[40:41], v[14:15], v[42:43] neg_lo:[0,1] neg_hi:[0,1]
    v_pk_add_f32 v[16:17], v[16:17], v[40:41]
    v_cvt_pk_bf16_f32 v76, v16, v17
    v_lshlrev_b32 v42, 16, v76
    v_and_b32 v43, s53, v76
    v_pk_add_f32 v[40:41], v[16:17], v[42:43] neg_lo:[0,1] neg_hi:[0,1]
    v_pk_add_f32 v[18:19], v[18:19], v[40:41]
    v_cvt_pk_bf16_f32 v77, v18, v19
    v_lshlrev_b32 v42, 16, v77
    v_and_b32 v43, s53, v77
    v_pk_add_f32 v[40:41], v[18:19], v[42:43] neg_lo:[0,1] neg_hi:[0,1]
    v_pk_add_f32 v[20:21], v[20:21], v[40:41]
    v_cvt_pk_bf16_f32 v78, v20, v21
    v_lshlrev_b32 v42, 16, v78
    v_and_b32 v43, s53, v78
    v_pk_add_f32 v[40:41], v[20:21], v[42:43] neg_lo:[0,1] neg_hi:[0,1]
    v_pk_add_f32 v[22:23], v[22:23], v[40:41]
    v_cvt_pk_bf16_f32 v79, v22, v23
    v_lshlrev_b32 v42, 16, v79
    v_and_b32 v43, s53, v79
    v_pk_add_f32 v[40:41], v[22:23], v[42:43] neg_lo:[0,1] neg_hi:[0,1]
    v_pk_add_f32 v[24:25], v[24:25], v[40:41]
    v_cvt_pk_bf16_f32 v80, v24, v25
    v_lshlrev_b32 v42, 16, v80
    v_and_b32 v43, s53, v80
    v_pk_add_f32 v[40:41], v[24:25], v[42:43] neg_lo:[0,1] neg_hi:[0,1]
    v_pk_add_f32 v[26:27], v[26:27], v[40:41]
    v_cvt_pk_bf16_f32 v81, v26, v27
    v_lshlrev_b32 v42, 16, v81
    v_and_b32 v43, s53, v81
    v_pk_add_f32 v[40:41], v[26:27], v[42:43] neg_lo:[0,1] neg_hi:[0,1]
    v_pk_add_f32 v[28:29], v[28:29], v[40:41]
    v_cvt_pk_bf16_f32 v82, v28, v29
    v_lshlrev_b32 v42, 16, v82
    v_and_b32 v43, s53, v82
    v_pk_add_f32 v[40:41], v[28:29], v[42:43] neg_lo:[0,1] neg_hi:[0,1]
    v_pk_add_f32 v[30:31], v[30:31], v[40:41]
    v_cvt_pk_bf16_f32 v83, v30, v31
    v_lshlrev_b32 v42, 16, v83
    v_and_b32 v43, s53, v83
    v_pk_add_f32 v[40:41], v[30:31], v[42:43] neg_lo:[0,1] neg_hi:[0,1]
    v_pk_add_f32 v[32:33], v[32:33], v[40:41]
    v_cvt_pk_bf16_f32 v84, v32, v33
    v_lshlrev_b32 v42, 16, v84
    v_and_b32 v43, s53, v84
    v_pk_add_f32 v[40:41], v[32:33], v[42:43] neg_lo:[0,1] neg_hi:[0,1]
    v_pk_add_f32 v[34:35], v[34:35], v[40:41]
    v_cvt_pk_bf16_f32 v85, v34, v35
    v_lshlrev_b32 v42, 16, v85
    v_and_b32 v43, s53, v85
    v_pk_add_f32 v[40:41], v[34:35], v[42:43] neg_lo:[0,1] neg_hi:[0,1]
    v_pk_add_f32 v[36:37], v[36:37], v[40:41]
    v_cvt_pk_bf16_f32 v86, v36, v37
    v_lshlrev_b32 v42, 16, v86
    v_and_b32 v43, s53, v86
    v_pk_add_f32 v[40:41], v[36:37], v[42:43] neg_lo:[0,1] neg_hi:[0,1]
    v_pk_add_f32 v[38:39], v[38:39], v[40:41]
    v_cvt_pk_bf16_f32 v87, v38, v39
    s_branch UST_29
UPL_30:
    ds_read_u16 v8, v63 offset:0
    ds_read_u16_d16_hi v24, v63 offset:72
    ds_read_u16 v9, v63 offset:144
    ds_read_u16_d16_hi v25, v63 offset:216
    ds_read_u16 v10, v64 offset:0
    ds_read_u16_d16_hi v26, v64 offset:72
    ds_read_u16 v11, v64 offset:144
    ds_read_u16_d16_hi v27, v64 offset:216
    s_add_u32 m0, s36, 98304
    s_add_u32 s38, s37, 262144
    buffer_load_dwordx4 v244, s[40:43], s38 offen lds
    ds_read_u16 v12, v63 offset:2304
    ds_read_u16_d16_hi v28, v63 offset:2376
    ds_read_u16 v13, v63 offset:2448
    ds_read_u16_d16_hi v29, v63 offset:2520
    ds_read_u16 v14, v64 offset:2304
    ds_read_u16_d16_hi v30, v64 offset:2376
    ds_read_u16 v15, v64 offset:2448
    ds_read_u16_d16_hi v31, v64 offset:2520
    s_add_u32 m0, s36, 106496
    s_add_u32 s38, s37, 294912
    buffer_load_dwordx4 v244, s[40:43], s38 offen lds
    ds_read_u16 v16, v63 offset:4608
    ds_read_u16_d16_hi v32, v63 offset:4680
    ds_read_u16 v17, v63 offset:4752
    ds_read_u16_d16_hi v33, v63 offset:4824
    ds_read_u16 v18, v64 offset:4608
    ds_read_u16_d16_hi v34, v64 offset:4680
    ds_read_u16 v19, v64 offset:4752
    ds_read_u16_d16_hi v35, v64 offset:4824
    s_add_u32 m0, s36, 114688
    s_add_u32 s38, s37, 327680
    buffer_load_dwordx4 v244, s[40:43], s38 offen lds
    ds_read_u16 v20, v63 offset:6912
    ds_read_u16_d16_hi v36, v63 offset:6984
    ds_read_u16 v21, v63 offset:7056
    ds_read_u16_d16_hi v37, v63 offset:7128
    ds_read_u16 v22, v64 offset:6912
    ds_read_u16_d16_hi v38, v64 offset:6984
    ds_read_u16 v23, v64 offset:7056
    ds_read_u16_d16_hi v39, v64 offset:7128
    s_waitcnt lgkmcnt(0)
    v_and_or_b32 v72, v24, s53, v8
    v_and_or_b32 v73, v25, s53, v9
    v_and_or_b32 v74, v26, s53, v10
    v_and_or_b32 v75, v27, s53, v11
    v_and_or_b32 v76, v28, s53, v12
    v_and_or_b32 v77, v29, s53, v13
    v_and_or_b32 v78, v30, s53, v14
    v_and_or_b32 v79, v31, s53, v15
    v_and_or_b32 v80, v32, s53, v16
    v_and_or_b32 v81, v33, s53, v17
    v_and_or_b32 v82, v34, s53, v18
    v_and_or_b32 v83, v35, s53, v19
    v_and_or_b32 v84, v36, s53, v20
    v_and_or_b32 v85, v37, s53, v21
    v_and_or_b32 v86, v38, s53, v22
    v_and_or_b32 v87, v39, s53, v23
    v_dot2_f32_bf16 v40, v72, s27, 0
    v_dot2_f32_bf16 v41, v73, s27, 0
    v_dot2_f32_bf16 v40, v74, s27, v40
    v_dot2_f32_bf16 v41, v75, s27, v41
    v_dot2_f32_bf16 v40, v76, s27, v40
    v_dot2_f32_bf16 v41, v77, s27, v41
    v_dot2_f32_bf16 v40, v78, s27, v40
    v_dot2_f32_bf16 v41, v79, s27, v41
    v_dot2_f32_bf16 v40, v80, s27, v40
    v_dot2_f32_bf16 v41, v81, s27, v41
    v_dot2_f32_bf16 v40, v82, s27, v40
    v_dot2_f32_bf16 v41, v83, s27, v41
    v_dot2_f32_bf16 v40, v84, s27, v40
    v_dot2_f32_bf16 v41, v85, s27, v41
    v_dot2_f32_bf16 v40, v86, s27, v40
    v_dot2_f32_bf16 v41, v87, s27, v41
    s_nop 2
    v_permlane32_swap_b32 v40, v41
    v_add_f32 v40, v40, v41
    v_mov_b32 v41, v40
    s_nop 1
    v_permlane32_swap_b32 v40, v41
    v_add_f32 v40, v40, v41
    v_mov_b32 v41, v40
    s_nop 1
    v_permlane16_swap_b32 v40, v41
    v_add_f32 v40, v40, v41
    ds_write_b32 v60, v40
    s_branch UST_29
UD_22:
    v_lshrrev_b32 v60, 3, v65
    v_and_b32 v65, 7, v65
    v_mul_u32_u24 v60, 160, v60
    v_lshl_add_u32 v60, v65, 4, v60
    v_add_u32 v60, 122880, v60
    s_waitcnt vmcnt(8)
    s_cmp_eq_u32 s20, 0
    s_cbranch_scc0 UW_31
    s_waitcnt vmcnt(0)
UW_31:
    ds_write_b128 v60, v[72:75] offset:0
    ds_write_b128 v60, v[76:79] offset:10240
    ds_write_b128 v60, v[80:83] offset:20480
    ds_write_b128 v60, v[84:87] offset:30720
    v_lshlrev_b32 v63, 1, v62
    v_mul_u32_u24 v63, 160, v63
    v_lshrrev_b32 v60, 2, v61
    v_lshl_add_u32 v63, v60, 4, v63
    v_and_b32 v60, 3, v61
    v_lshl_add_u32 v63, v60, 1, v63
    s_bfe_u32 s46, s3, 0x10001
    s_lshl_b32 s46, s46, 6
    s_lshl_b32 s96, s98, 3
    s_add_u32 s46, s46, s96
    s_add_u32 s46, s46, 122880
    v_add_u32 v63, s46, v63
    s_lshr_b32 s46, s3, 2
    s_mul_i32 s46, s46, 8960
    v_add_u32 v64, s46, v63
    v_add_u32 v65, s46, v64
    s_sub_u32 s96, s55, 112
    s_and_b32 s97, s96, 7
    s_lshr_b32 s96, s96, 3
    s_lshl_b32 s51, s97, 3
    s_add_u32 s51, s51, s96
    s_mul_i32 s51, s51, 28
    s_add_u32 s51, s51, s3
    s_lshl_b32 s51, s51, 10
    s_add_u32 s51, s51, 4784128
    s_mov_b32 s52, 8192
    s_mov_b32 s53, 0xffff0000
    s_waitcnt lgkmcnt(0)
    s_barrier
    ds_read_u16 v8, v64 offset:0
    ds_read_u16_d16_hi v24, v64 offset:160
    ds_read_u16 v9, v64 offset:1280
    ds_read_u16_d16_hi v25, v64 offset:1440
    ds_read_u16 v10, v64 offset:2560
    ds_read_u16_d16_hi v26, v64 offset:2720
    ds_read_u16 v11, v64 offset:3840
    ds_read_u16_d16_hi v27, v64 offset:4000
    s_add_u32 m0, s36, 98304
    s_add_u32 s38, s37, 262144
    buffer_load_dwordx4 v244, s[40:43], s38 offen lds
    ds_read_u16 v12, v64 offset:17920
    ds_read_u16_d16_hi v28, v64 offset:18080
    ds_read_u16 v13, v64 offset:19200
    ds_read_u16_d16_hi v29, v64 offset:19360
    ds_read_u16 v14, v64 offset:20480
    ds_read_u16_d16_hi v30, v64 offset:20640
    ds_read_u16 v15, v64 offset:21760
    ds_read_u16_d16_hi v31, v64 offset:21920
    s_add_u32 m0, s36, 106496
    s_add_u32 s38, s37, 294912
    buffer_load_dwordx4 v244, s[40:43], s38 offen lds
    ds_read_u16 v16, v65 offset:5120
    ds_read_u16_d16_hi v32, v65 offset:5280
    ds_read_u16 v17, v65 offset:6400
    ds_read_u16_d16_hi v33, v65 offset:6560
    ds_read_u16 v18, v65 offset:14080
    ds_read_u16_d16_hi v34, v65 offset:14240
    ds_read_u16 v19, v65 offset:15360
    ds_read_u16_d16_hi v35, v65 offset:15520
    s_add_u32 m0, s36, 114688
    s_add_u32 s38, s37, 327680
    buffer_load_dwordx4 v244, s[40:43], s38 offen lds
    ds_read_u16 v20, v63 offset:7680
    ds_read_u16_d16_hi v36, v63 offset:7840
    ds_read_u16 v21, v63 offset:16640
    ds_read_u16_d16_hi v37, v63 offset:16800
    ds_read_u16 v22, v63 offset:25600
    ds_read_u16_d16_hi v38, v63 offset:25760
    ds_read_u16 v23, v63 offset:34560
    ds_read_u16_d16_hi v39, v63 offset:34720
    s_waitcnt lgkmcnt(0)
    v_and_or_b32 v72, v24, s53, v8
    v_and_or_b32 v73, v25, s53, v9
    v_and_or_b32 v74, v26, s53, v10
    v_and_or_b32 v75, v27, s53, v11
    v_and_or_b32 v76, v28, s53, v12
    v_and_or_b32 v77, v29, s53, v13
    v_and_or_b32 v78, v30, s53, v14
    v_and_or_b32 v79, v31, s53, v15
    v_and_or_b32 v80, v32, s53, v16
    v_and_or_b32 v81, v33, s53, v17
    v_and_or_b32 v82, v34, s53, v18
    v_and_or_b32 v83, v35, s53, v19
    v_and_or_b32 v84, v36, s53, v20
    v_and_or_b32 v85, v37, s53, v21
    v_and_or_b32 v86, v38, s53, v22
    v_and_or_b32 v87, v39, s53, v23
UST_29:
    s_branch UX_21
UNONE_26:
    s_add_u32 m0, s36, 98304
    s_add_u32 s38, s37, 262144
    buffer_load_dwordx4 v244, s[40:43], s38 offen lds
    s_add_u32 m0, s36, 106496
    s_add_u32 s38, s37, 294912
    buffer_load_dwordx4 v244, s[40:43], s38 offen lds
    s_add_u32 m0, s36, 114688
    s_add_u32 s38, s37, 327680
    buffer_load_dwordx4 v244, s[40:43], s38 offen lds
UX_21:
    v_lshrrev_b32 v5, 4, v0
    v_bfe_u32 v6, v0, 2, 2
    v_lshl_add_u32 v2, v5, 3, v6
    v_lshlrev_b32 v2, 8, v2
    v_and_b32 v5, 1, v5
    v_lshl_add_u32 v5, v6, 1, v5
    v_xor_b32 v5, s3, v5
    v_lshl_add_u32 v2, v5, 5, v2
    v_and_b32 v6, 3, v0
    v_lshl_add_u32 v2, v6, 3, v2
    v_add_u32 v2, 32768, v2
    v_add_u32 v4, 65536, v2
    v_mul_f32 v232, 1052289595, v232
    v_mul_f32 v233, 1052289595, v233
    s_waitcnt vmcnt(0) lgkmcnt(0)
    s_cmp_eq_u32 s3, 7
    s_cbranch_scc0 NOW7C_32
    s_waitcnt vmcnt(0)
    v_cmp_gt_u32 vcc, s47, v250
    s_cbranch_vccz NOW7C_32
    s_mov_b32 s46, 262144
POLL_33:
    buffer_load_dword v250, v249, s[60:63], 0 offen sc1
    s_waitcnt vmcnt(0)
    v_cmp_gt_u32 vcc, s47, v250
    s_cbranch_vccz POLLD_34
    s_sub_u32 s46, s46, 1
    s_cbranch_scc0 POLL_33
POLLD_34:
NOW7C_32:
    s_cmp_eq_u32 s3, 7
    s_cbranch_scc0 NOW7_35
    buffer_load_dword v251, v248, s[8:11], 0 offen sc1
NOW7_35:
    s_barrier
    v_and_b32 v60, 31, v0
    v_lshlrev_b32 v61, 2, v60
    v_add_u32 v62, 159744, v61
    s_cmp_eq_u32 s3, 4
    s_cbranch_scc0 NOCS_36
    s_sub_u32 s96, s55, 192
    s_cmp_ge_u32 s96, 17
    s_cbranch_scc1 NOCS_36
    ds_read_b32 v56, v62 offset:0
    ds_read_b32 v57, v62 offset:128
    ds_read_b32 v58, v62 offset:256
    ds_read_b32 v59, v62 offset:384
    s_lshl_b32 s96, s96, 7
    s_add_u32 s96, s96, 7446528
    s_waitcnt lgkmcnt(0)
    v_pk_add_f32 v[56:57], v[56:57], v[58:59]
    v_add_f32 v56, v56, v57
    s_mov_b32 exec_hi, 0
    buffer_store_dword v56, v61, s[8:11], s96 offen sc1
    s_mov_b32 exec_hi, -1
NOCS_36:
    s_add_u32 m0, s36, 122880
    s_add_u32 s38, s37, 360448
    buffer_load_dwordx4 v244, s[40:43], s38 offen lds
    s_add_u32 m0, s36, 131072
    s_add_u32 s38, s37, 393216
    buffer_load_dwordx4 v244, s[40:43], s38 offen lds
    s_add_u32 m0, s36, 139264
    s_add_u32 s38, s37, 425984
    buffer_load_dwordx4 v244, s[40:43], s38 offen lds
    s_add_u32 m0, s36, 147456
    s_add_u32 s38, s37, 458752
    buffer_load_dwordx4 v244, s[40:43], s38 offen lds
    s_add_u32 m0, s36, 155648
    s_add_u32 s38, s37, 491520
    buffer_load_dwordx4 v244, s[40:43], s38 offen lds
    ds_read_b64_tr_b16 v[40:41], v2 offset:0
    ds_read_b64_tr_b16 v[42:43], v2 offset:1024
    ds_read_b128 v[8:11], v1 offset:0
    ds_read_b128 v[12:15], v1 offset:16384
    ds_read_b64_tr_b16 v[44:45], v2 offset:8192
    ds_read_b64_tr_b16 v[46:47], v2 offset:9216
    ds_read_b128 v[16:19], v1 offset:1024
    ds_read_b128 v[20:23], v1 offset:17408
    ds_read_b64_tr_b16 v[48:49], v2 offset:16384
    ds_read_b64_tr_b16 v[50:51], v2 offset:17408
    ds_read_b128 v[24:27], v1 offset:2048
    ds_read_b128 v[28:31], v1 offset:18432
    s_waitcnt lgkmcnt(8)
    v_mfma_f32_16x16x32_bf16 v[196:199], v[40:43], v[8:11], 0
    v_mfma_f32_16x16x32_bf16 v[200:203], v[40:43], v[12:15], 0
    v_mfma_f32_16x16x32_bf16 v[204:207], v[40:43], v[240:243], 0
    ds_read_b64_tr_b16 v[52:53], v2 offset:24576
    ds_read_b64_tr_b16 v[54:55], v2 offset:25600
    ds_read_b128 v[32:35], v1 offset:3072
    ds_read_b128 v[36:39], v1 offset:19456
    s_cmp_ge_u32 s55, 209
    s_cbranch_scc1 USX_39
    buffer_store_dwordx4 v[72:75], v66, s[8:11], s51 offen sc1
    s_add_u32 s51, s51, s52
USX_39:
    s_waitcnt lgkmcnt(8)
    v_mfma_f32_16x16x32_bf16 v[196:199], v[44:47], v[16:19], v[196:199]
    v_mfma_f32_16x16x32_bf16 v[200:203], v[44:47], v[20:23], v[200:203]
    v_mfma_f32_16x16x32_bf16 v[204:207], v[44:47], v[240:243], v[204:207]
    ds_read_b64_tr_b16 v[40:41], v2 offset:32768
    ds_read_b64_tr_b16 v[42:43], v2 offset:33792
    ds_read_b128 v[8:11], v1 offset:4096
    ds_read_b128 v[12:15], v1 offset:20480
    s_cmp_ge_u32 s55, 209
    s_cbranch_scc1 USX_40
    buffer_store_dwordx4 v[76:79], v66, s[8:11], s51 offen sc1
    s_add_u32 s51, s51, s52
USX_40:
    s_waitcnt lgkmcnt(8)
    v_mfma_f32_16x16x32_bf16 v[196:199], v[48:51], v[24:27], v[196:199]
    v_mfma_f32_16x16x32_bf16 v[200:203], v[48:51], v[28:31], v[200:203]
    v_mfma_f32_16x16x32_bf16 v[204:207], v[48:51], v[240:243], v[204:207]
    ds_read_b64_tr_b16 v[44:45], v2 offset:40960
    ds_read_b64_tr_b16 v[46:47], v2 offset:41984
    ds_read_b128 v[16:19], v1 offset:5120
    ds_read_b128 v[20:23], v1 offset:21504
    s_cmp_ge_u32 s55, 209
    s_cbranch_scc1 USX_41
    buffer_store_dwordx4 v[80:83], v66, s[8:11], s51 offen sc1
    s_add_u32 s51, s51, s52
USX_41:
    s_waitcnt lgkmcnt(8)
    v_mfma_f32_16x16x32_bf16 v[196:199], v[52:55], v[32:35], v[196:199]
    v_mfma_f32_16x16x32_bf16 v[200:203], v[52:55], v[36:39], v[200:203]
    v_mfma_f32_16x16x32_bf16 v[204:207], v[52:55], v[240:243], v[204:207]
    ds_read_b64_tr_b16 v[48:49], v2 offset:49152
    ds_read_b64_tr_b16 v[50:51], v2 offset:50176
    ds_read_b128 v[24:27], v1 offset:6144
    ds_read_b128 v[28:31], v1 offset:22528
    s_cmp_ge_u32 s55, 209
    s_cbranch_scc1 USX_42
    s_cmp_eq_u32 s52, 8192
    s_cselect_b32 s96, s3, 0
    s_cmp_ge_u32 s96, 4
    s_cbranch_scc1 USX_42
    buffer_store_dwordx4 v[84:87], v66, s[8:11], s51 offen sc1
USX_42:
    s_waitcnt lgkmcnt(8)
    v_mfma_f32_16x16x32_bf16 v[196:199], v[40:43], v[8:11], v[196:199]
    v_mfma_f32_16x16x32_bf16 v[200:203], v[40:43], v[12:15], v[200:203]
    v_mfma_f32_16x16x32_bf16 v[204:207], v[40:43], v[240:243], v[204:207]
    ds_read_b64_tr_b16 v[52:53], v2 offset:57344
    ds_read_b64_tr_b16 v[54:55], v2 offset:58368
    ds_read_b128 v[32:35], v1 offset:7168
    ds_read_b128 v[36:39], v1 offset:23552
    s_waitcnt lgkmcnt(8)
    v_mfma_f32_16x16x32_bf16 v[196:199], v[44:47], v[16:19], v[196:199]
    v_mfma_f32_16x16x32_bf16 v[200:203], v[44:47], v[20:23], v[200:203]
    v_mfma_f32_16x16x32_bf16 v[204:207], v[44:47], v[240:243], v[204:207]
    ds_read_b64_tr_b16 v[40:41], v4 offset:0
    ds_read_b64_tr_b16 v[42:43], v4 offset:1024
    ds_read_b128 v[8:11], v1 offset:8192
    ds_read_b128 v[12:15], v1 offset:24576
    s_waitcnt lgkmcnt(8)
    v_mfma_f32_16x16x32_bf16 v[196:199], v[48:51], v[24:27], v[196:199]
    v_mfma_f32_16x16x32_bf16 v[200:203], v[48:51], v[28:31], v[200:203]
    v_mfma_f32_16x16x32_bf16 v[204:207], v[48:51], v[240:243], v[204:207]
    ds_read_b64_tr_b16 v[44:45], v4 offset:8192
    ds_read_b64_tr_b16 v[46:47], v4 offset:9216
    ds_read_b128 v[16:19], v1 offset:9216
    ds_read_b128 v[20:23], v1 offset:25600
    s_waitcnt lgkmcnt(8)
    v_mfma_f32_16x16x32_bf16 v[196:199], v[52:55], v[32:35], v[196:199]
    v_mfma_f32_16x16x32_bf16 v[200:203], v[52:55], v[36:39], v[200:203]
    v_mfma_f32_16x16x32_bf16 v[204:207], v[52:55], v[240:243], v[204:207]
    ds_read_b64_tr_b16 v[48:49], v4 offset:16384
    ds_read_b64_tr_b16 v[50:51], v4 offset:17408
    ds_read_b128 v[24:27], v1 offset:10240
    ds_read_b128 v[28:31], v1 offset:26624
    s_waitcnt lgkmcnt(8)
    v_mfma_f32_16x16x32_bf16 v[196:199], v[40:43], v[8:11], v[196:199]
    v_mfma_f32_16x16x32_bf16 v[200:203], v[40:43], v[12:15], v[200:203]
    v_mfma_f32_16x16x32_bf16 v[204:207], v[40:43], v[240:243], v[204:207]
    s_waitcnt lgkmcnt(4)
    v_mfma_f32_16x16x32_bf16 v[196:199], v[44:47], v[16:19], v[196:199]
    v_mfma_f32_16x16x32_bf16 v[200:203], v[44:47], v[20:23], v[200:203]
    v_mfma_f32_16x16x32_bf16 v[204:207], v[44:47], v[240:243], v[204:207]
    s_waitcnt lgkmcnt(0)
    v_mfma_f32_16x16x32_bf16 v[196:199], v[48:51], v[24:27], v[196:199]
    v_mfma_f32_16x16x32_bf16 v[200:203], v[48:51], v[28:31], v[200:203]
    v_mfma_f32_16x16x32_bf16 v[204:207], v[48:51], v[240:243], v[204:207]
    s_cmp_ge_u32 s55, 209
    s_cbranch_scc1 WU0_43
    s_waitcnt vmcnt(3)
    s_branch WU1_44
WU0_43:
    s_waitcnt vmcnt(0)
WU1_44:
    s_cmp_eq_u32 s3, 7
    s_cbranch_scc0 NOW7C_45
    s_waitcnt vmcnt(63)
    v_cmp_gt_u32 vcc, s47, v251
    s_cbranch_vccz NOW7C_45
    s_mov_b32 s46, 262144
POLL_46:
    buffer_load_dword v251, v248, s[8:11], 0 offen sc1
    s_waitcnt vmcnt(0)
    v_cmp_gt_u32 vcc, s47, v251
    s_cbranch_vccz POLLD_47
    s_sub_u32 s46, s46, 1
    s_cbranch_scc0 POLL_46
POLLD_47:
NOW7C_45:
    s_barrier
    s_lshl_b32 s33, s3, 12
    s_add_u32 m0, s33, 32768
    s_add_u32 s31, s33, s49
    buffer_load_dwordx4 v1, s[8:11], s31 offen offset:0 sc1 lds
    buffer_load_dwordx4 v1, s[8:11], s31 offen offset:1024 sc1 lds
    buffer_load_dwordx4 v1, s[8:11], s31 offen offset:2048 sc1 lds
    buffer_load_dwordx4 v1, s[8:11], s31 offen offset:3072 sc1 lds
    ds_read_b64_tr_b16 v[52:53], v4 offset:24576
    ds_read_b64_tr_b16 v[54:55], v4 offset:25600
    ds_read_b128 v[32:35], v1 offset:11264
    ds_read_b128 v[36:39], v1 offset:27648
    ds_read_b64_tr_b16 v[40:41], v4 offset:32768
    ds_read_b64_tr_b16 v[42:43], v4 offset:33792
    ds_read_b128 v[8:11], v1 offset:12288
    ds_read_b128 v[12:15], v1 offset:28672
    ds_read_b64_tr_b16 v[44:45], v4 offset:40960
    ds_read_b64_tr_b16 v[46:47], v4 offset:41984
    ds_read_b128 v[16:19], v1 offset:13312
    ds_read_b128 v[20:23], v1 offset:29696
    s_waitcnt lgkmcnt(8)
    v_mfma_f32_16x16x32_bf16 v[196:199], v[52:55], v[32:35], v[196:199]
    v_mfma_f32_16x16x32_bf16 v[200:203], v[52:55], v[36:39], v[200:203]
    v_mfma_f32_16x16x32_bf16 v[204:207], v[52:55], v[240:243], v[204:207]
    ds_read_b64_tr_b16 v[48:49], v4 offset:49152
    ds_read_b64_tr_b16 v[50:51], v4 offset:50176
    ds_read_b128 v[24:27], v1 offset:14336
    ds_read_b128 v[28:31], v1 offset:30720
    s_waitcnt lgkmcnt(8)
    v_mfma_f32_16x16x32_bf16 v[196:199], v[40:43], v[8:11], v[196:199]
    v_mfma_f32_16x16x32_bf16 v[200:203], v[40:43], v[12:15], v[200:203]
    v_mfma_f32_16x16x32_bf16 v[204:207], v[40:43], v[240:243], v[204:207]
    ds_read_b64_tr_b16 v[52:53], v4 offset:57344
    ds_read_b64_tr_b16 v[54:55], v4 offset:58368
    ds_read_b128 v[32:35], v1 offset:15360
    ds_read_b128 v[36:39], v1 offset:31744
    s_waitcnt lgkmcnt(8)
    v_mfma_f32_16x16x32_bf16 v[196:199], v[44:47], v[16:19], v[196:199]
    v_mfma_f32_16x16x32_bf16 v[200:203], v[44:47], v[20:23], v[200:203]
    v_mfma_f32_16x16x32_bf16 v[204:207], v[44:47], v[240:243], v[204:207]
    s_waitcnt lgkmcnt(4)
    v_mfma_f32_16x16x32_bf16 v[196:199], v[48:51], v[24:27], v[196:199]
    v_mfma_f32_16x16x32_bf16 v[200:203], v[48:51], v[28:31], v[200:203]
    v_mfma_f32_16x16x32_bf16 v[204:207], v[48:51], v[240:243], v[204:207]
    s_waitcnt lgkmcnt(0)
    v_mfma_f32_16x16x32_bf16 v[196:199], v[52:55], v[32:35], v[196:199]
    v_mfma_f32_16x16x32_bf16 v[200:203], v[52:55], v[36:39], v[200:203]
    v_mfma_f32_16x16x32_bf16 v[204:207], v[52:55], v[240:243], v[204:207]
    s_nop 7
    v_fma_f32 v196, -v234, v204, v196
    v_fma_f32 v197, -v234, v205, v197
    v_fma_f32 v198, -v234, v206, v198
    v_fma_f32 v199, -v234, v207, v199
    v_fma_f32 v200, -v235, v204, v200
    v_fma_f32 v201, -v235, v205, v201
    v_fma_f32 v202, -v235, v206, v202
    v_fma_f32 v203, -v235, v207, v203
    s_branch M_ATTN
M_LAYER:
    s_mov_b32 s46, 262144
POLL_48:
    buffer_load_dword v3, v2, s[8:11], 0 offen sc1
    s_waitcnt vmcnt(0)
    v_cmp_gt_u32 vcc, s47, v3
    s_cbranch_vccz POLLD_49
    s_sub_u32 s46, s46, 1
    s_cbranch_scc0 POLL_48
POLLD_49:
    s_lshl_b32 s30, s3, 11
    s_lshl_b32 s31, s19, 15
    s_add_u32 s31, s31, s30
    s_add_u32 s31, s31, 8388608
    s_add_u32 m0, s30, 0
    s_add_u32 s32, s31, 16384
    buffer_load_dwordx4 v1, s[8:11], s31 offen sc1 lds
    buffer_load_dwordx4 v1, s[8:11], s31 offen offset:1024 sc1 lds
    s_add_u32 m0, s30, 16384
    s_nop 0
    buffer_load_dwordx4 v1, s[8:11], s32 offen sc1 lds
    buffer_load_dwordx4 v1, s[8:11], s32 offen offset:1024 sc1 lds
    v_lshrrev_b32 v2, 4, v0
    v_lshlrev_b32 v2, 14, v2
    v_and_b32 v3, 15, v0
    v_lshl_add_u32 v2, v3, 4, v2
    s_lshl_b32 s31, s3, 15
    s_lshl_b32 s32, s19, 8
    s_add_u32 s31, s31, s32
    s_add_u32 s31, s31, 6881280
    s_lshl_b32 s30, s3, 9
    s_add_u32 m0, s30, 159744
    s_mov_b32 exec_hi, 0
    buffer_load_dwordx4 v2, s[8:11], s31 offen sc1 lds
    s_mov_b32 exec_hi, -1
    v_lshrrev_b32 v2, 5, v0
    v_lshlrev_b32 v2, 11, v2
    v_and_b32 v3, 31, v0
    v_lshl_add_u32 v2, v3, 3, v2
    v_add_u32 v2, 159744, v2
    s_and_b32 s30, s3, 1
    s_lshl_b32 s30, s30, 14
    v_add_u32 v4, s30, v1
    v_mov_b32 v6, 0
    v_mov_b32 v5, 139264
    ds_write_b32 v5, v6
    v_and_b32 v5, 15, v0
    v_lshrrev_b32 v6, 4, v0
    v_lshrrev_b32 v7, 5, v0
    v_lshlrev_b32 v7, 9, v7
    v_lshl_add_u32 v7, v5, 4, v7
    v_and_b32 v5, 1, v6
    v_lshl_add_u32 v7, v5, 3, v7
    s_lshl_b32 s31, s19, 11
    s_add_u32 s31, s31, s49
    s_and_b32 s30, s3, 1
    s_lshl_b32 s30, s30, 8
    s_add_u32 s31, s31, s30
    v_lshlrev_b32 v5, 4, v6
    s_lshl_b32 s32, s20, 3
    s_add_u32 s32, s32, s3
    s_lshl_b32 s32, s32, 6
    s_add_u32 s32, s32, 7446528
    buffer_load_dwordx4 v[204:207], v5, s[8:11], s32 offen
    s_mov_b32 s32, 7448576
    v_and_b32 v3, 15, v0
    v_lshlrev_b32 v3, 2, v3
    s_cmp_eq_u32 s48, 0
    s_cbranch_scc1 NOCK_50
    buffer_load_dwordx4 v[240:243], v5, s[8:11], s32 offen
    buffer_load_dword v244, v3, s[8:11], s32 offen offset:64
NOCK_50:
    s_bitcmp1_b32 s3, 0
    s_cselect_b64 s[34:35], -1, 0
    s_waitcnt vmcnt(0) lgkmcnt(0)
    s_barrier
    s_cmp_eq_u32 s48, 0
    s_cbranch_scc1 NOKVW_54
    s_setprio 2
    ds_read_b128 v[132:135], v4 offset:0
    ds_read_b128 v[136:139], v4 offset:1024
    ds_read_b128 v[140:143], v4 offset:2048
    ds_read_b128 v[144:147], v4 offset:3072
    ds_read2_b64 v[216:219], v2 offset0:0 offset1:32
    ds_read2_b64 v[220:223], v2 offset0:64 offset1:96
    ds_read2_b64 v[224:227], v2 offset0:128 offset1:160
    ds_read2_b64 v[228:231], v2 offset0:192 offset1:224
    ds_read_b128 v[148:151], v4 offset:4096
    ds_read_b128 v[152:155], v4 offset:5120
    ds_read_b128 v[156:159], v4 offset:6144
    ds_read_b128 v[160:163], v4 offset:7168
    ds_read_b128 v[164:167], v4 offset:8192
    ds_read_b128 v[168:171], v4 offset:9216
    ds_read_b128 v[172:175], v4 offset:10240
    s_cmp_ge_u32 s3, 2
    s_cbranch_scc1 ISV_52
    s_waitcnt lgkmcnt(14)
    v_mfma_f32_16x16x32_bf16 v[208:211], v[68:71], v[132:135], 0
    ds_read_b128 v[176:179], v4 offset:11264
    s_waitcnt lgkmcnt(14)
    v_mfma_f32_16x16x32_bf16 v[212:215], v[72:75], v[136:139], 0
    ds_read_b128 v[180:183], v4 offset:12288
    s_waitcnt lgkmcnt(14)
    v_mfma_f32_16x16x32_bf16 v[208:211], v[76:79], v[140:143], v[208:211]
    ds_read_b128 v[184:187], v4 offset:13312
    s_waitcnt lgkmcnt(14)
    v_mfma_f32_16x16x32_bf16 v[212:215], v[80:83], v[144:147], v[212:215]
    ds_read_b128 v[188:191], v4 offset:14336
    s_waitcnt lgkmcnt(10)
    v_mfma_f32_16x16x32_bf16 v[208:211], v[84:87], v[148:151], v[208:211]
    ds_read_b128 v[192:195], v4 offset:15360
    v_pk_add_f32 v[216:217], v[216:217], v[218:219]
    v_pk_add_f32 v[220:221], v[220:221], v[222:223]
    s_waitcnt lgkmcnt(10)
    v_mfma_f32_16x16x32_bf16 v[212:215], v[88:91], v[152:155], v[212:215]
    v_pk_add_f32 v[224:225], v[224:225], v[226:227]
    v_pk_add_f32 v[228:229], v[228:229], v[230:231]
    v_pk_add_f32 v[216:217], v[216:217], v[220:221]
    s_waitcnt lgkmcnt(9)
    v_mfma_f32_16x16x32_bf16 v[208:211], v[92:95], v[156:159], v[208:211]
    v_pk_add_f32 v[224:225], v[224:225], v[228:229]
    v_pk_add_f32 v[216:217], v[216:217], v[224:225]
    s_waitcnt lgkmcnt(8)
    v_mfma_f32_16x16x32_bf16 v[212:215], v[96:99], v[160:163], v[212:215]
    v_mov_b32 v218, v216
    v_mov_b32 v219, v217
    s_nop 1
    s_waitcnt lgkmcnt(7)
    v_mfma_f32_16x16x32_bf16 v[208:211], v[100:103], v[164:167], v[208:211]
    v_permlane32_swap_b32 v216, v218
    v_permlane32_swap_b32 v217, v219
    v_add_f32 v216, v216, v218
    s_waitcnt lgkmcnt(6)
    v_mfma_f32_16x16x32_bf16 v[212:215], v[104:107], v[168:171], v[212:215]
    v_add_f32 v217, v217, v219
    v_mul_f32 v216, 0x3b000000, v216
    s_waitcnt lgkmcnt(5)
    v_mfma_f32_16x16x32_bf16 v[208:211], v[108:111], v[172:175], v[208:211]
    v_mul_f32 v217, 0x3b000000, v217
    v_fma_f32 v217, -v216, v216, v217
    v_max_f32 v217, 0, v217
    s_waitcnt lgkmcnt(4)
    v_mfma_f32_16x16x32_bf16 v[212:215], v[112:115], v[176:179], v[212:215]
    v_add_f32 v217, 925353388, v217
    v_rsq_f32 v232, v217
    s_waitcnt lgkmcnt(3)
    v_mfma_f32_16x16x32_bf16 v[208:211], v[116:119], v[180:183], v[208:211]
    v_mov_b32 v234, v216
    v_mov_b32 v235, v216
    v_mov_b32 v233, v232
    s_waitcnt lgkmcnt(2)
    v_mfma_f32_16x16x32_bf16 v[212:215], v[120:123], v[184:187], v[212:215]
    s_nop 1
    v_permlane16_swap_b32 v232, v233
    v_permlane16_swap_b32 v234, v235
    s_waitcnt lgkmcnt(1)
    v_mfma_f32_16x16x32_bf16 v[208:211], v[124:127], v[188:191], v[208:211]
    v_cndmask_b32 v216, v232, v233, s[34:35]
    v_cndmask_b32 v217, v234, v235, s[34:35]
    s_waitcnt lgkmcnt(0)
    v_mfma_f32_16x16x32_bf16 v[212:215], v[128:131], v[192:195], v[212:215]
    s_nop 7
    v_pk_add_f32 v[208:209], v[208:209], v[212:213]
    v_pk_add_f32 v[210:211], v[210:211], v[214:215]
    v_fma_f32 v208, -v217, v240, v208
    v_fma_f32 v209, -v217, v241, v209
    v_fma_f32 v210, -v217, v242, v210
    v_fma_f32 v211, -v217, v243, v211
    v_mul_f32 v208, v208, v216
    v_mul_f32 v209, v209, v216
    v_mul_f32 v210, v210, v216
    v_mul_f32 v211, v211, v216
    s_branch KVST_53
NOKVW_54:
    ds_read2_b64 v[216:219], v2 offset0:0 offset1:32
    ds_read2_b64 v[220:223], v2 offset0:64 offset1:96
    ds_read2_b64 v[224:227], v2 offset0:128 offset1:160
    ds_read2_b64 v[228:231], v2 offset0:192 offset1:224
    s_waitcnt lgkmcnt(0)
    v_pk_add_f32 v[216:217], v[216:217], v[218:219]
    v_pk_add_f32 v[220:221], v[220:221], v[222:223]
    v_pk_add_f32 v[224:225], v[224:225], v[226:227]
    v_pk_add_f32 v[228:229], v[228:229], v[230:231]
    v_pk_add_f32 v[216:217], v[216:217], v[220:221]
    v_pk_add_f32 v[224:225], v[224:225], v[228:229]
    v_pk_add_f32 v[216:217], v[216:217], v[224:225]
    v_mov_b32 v218, v216
    v_mov_b32 v219, v217
    s_nop 1
    v_permlane32_swap_b32 v216, v218
    v_permlane32_swap_b32 v217, v219
    v_add_f32 v216, v216, v218
    v_add_f32 v217, v217, v219
    v_mul_f32 v216, 0x3b000000, v216
    v_mul_f32 v217, 0x3b000000, v217
    v_fma_f32 v217, -v216, v216, v217
    v_max_f32 v217, 0, v217
    v_add_f32 v217, 925353388, v217
    v_rsq_f32 v232, v217
    v_mov_b32 v234, v216
    v_mov_b32 v235, v216
    v_mov_b32 v233, v232
    s_nop 1
    v_permlane16_swap_b32 v232, v233
    v_permlane16_swap_b32 v234, v235
    s_branch NOKV_51
ISV_52:
    s_waitcnt lgkmcnt(14)
    v_mfma_f32_16x16x32_bf16 v[208:211], v[132:135], v[68:71], 0
    ds_read_b128 v[176:179], v4 offset:11264
    s_waitcnt lgkmcnt(14)
    v_mfma_f32_16x16x32_bf16 v[212:215], v[136:139], v[72:75], 0
    ds_read_b128 v[180:183], v4 offset:12288
    s_waitcnt lgkmcnt(14)
    v_mfma_f32_16x16x32_bf16 v[208:211], v[140:143], v[76:79], v[208:211]
    ds_read_b128 v[184:187], v4 offset:13312
    s_waitcnt lgkmcnt(14)
    v_mfma_f32_16x16x32_bf16 v[212:215], v[144:147], v[80:83], v[212:215]
    ds_read_b128 v[188:191], v4 offset:14336
    s_waitcnt lgkmcnt(10)
    v_mfma_f32_16x16x32_bf16 v[208:211], v[148:151], v[84:87], v[208:211]
    ds_read_b128 v[192:195], v4 offset:15360
    v_pk_add_f32 v[216:217], v[216:217], v[218:219]
    v_pk_add_f32 v[220:221], v[220:221], v[222:223]
    s_waitcnt lgkmcnt(10)
    v_mfma_f32_16x16x32_bf16 v[212:215], v[152:155], v[88:91], v[212:215]
    v_pk_add_f32 v[224:225], v[224:225], v[226:227]
    v_pk_add_f32 v[228:229], v[228:229], v[230:231]
    v_pk_add_f32 v[216:217], v[216:217], v[220:221]
    s_waitcnt lgkmcnt(9)
    v_mfma_f32_16x16x32_bf16 v[208:211], v[156:159], v[92:95], v[208:211]
    v_pk_add_f32 v[224:225], v[224:225], v[228:229]
    v_pk_add_f32 v[216:217], v[216:217], v[224:225]
    s_waitcnt lgkmcnt(8)
    v_mfma_f32_16x16x32_bf16 v[212:215], v[160:163], v[96:99], v[212:215]
    v_mov_b32 v218, v216
    v_mov_b32 v219, v217
    s_nop 1
    s_waitcnt lgkmcnt(7)
    v_mfma_f32_16x16x32_bf16 v[208:211], v[164:167], v[100:103], v[208:211]
    v_permlane32_swap_b32 v216, v218
    v_permlane32_swap_b32 v217, v219
    v_add_f32 v216, v216, v218
    s_waitcnt lgkmcnt(6)
    v_mfma_f32_16x16x32_bf16 v[212:215], v[168:171], v[104:107], v[212:215]
    v_add_f32 v217, v217, v219
    v_mul_f32 v216, 0x3b000000, v216
    s_waitcnt lgkmcnt(5)
    v_mfma_f32_16x16x32_bf16 v[208:211], v[172:175], v[108:111], v[208:211]
    v_mul_f32 v217, 0x3b000000, v217
    v_fma_f32 v217, -v216, v216, v217
    v_max_f32 v217, 0, v217
    s_waitcnt lgkmcnt(4)
    v_mfma_f32_16x16x32_bf16 v[212:215], v[176:179], v[112:115], v[212:215]
    v_add_f32 v217, 925353388, v217
    v_rsq_f32 v232, v217
    s_waitcnt lgkmcnt(3)
    v_mfma_f32_16x16x32_bf16 v[208:211], v[180:183], v[116:119], v[208:211]
    v_mov_b32 v234, v216
    v_mov_b32 v235, v216
    v_mov_b32 v233, v232
    s_waitcnt lgkmcnt(2)
    v_mfma_f32_16x16x32_bf16 v[212:215], v[184:187], v[120:123], v[212:215]
    s_nop 1
    v_permlane16_swap_b32 v232, v233
    v_permlane16_swap_b32 v234, v235
    s_waitcnt lgkmcnt(1)
    v_mfma_f32_16x16x32_bf16 v[208:211], v[188:191], v[124:127], v[208:211]
    v_cndmask_b32 v216, v232, v233, s[34:35]
    v_cndmask_b32 v217, v234, v235, s[34:35]
    s_waitcnt lgkmcnt(0)
    v_mfma_f32_16x16x32_bf16 v[212:215], v[192:195], v[128:131], v[212:215]
    ds_bpermute_b32 v220, v5, v216 offset:0
    ds_bpermute_b32 v224, v5, v217 offset:0
    ds_bpermute_b32 v221, v5, v216 offset:4
    ds_bpermute_b32 v225, v5, v217 offset:4
    ds_bpermute_b32 v222, v5, v216 offset:8
    ds_bpermute_b32 v226, v5, v217 offset:8
    ds_bpermute_b32 v223, v5, v216 offset:12
    ds_bpermute_b32 v227, v5, v217 offset:12
    s_add_u32 s31, s31, 1024
    v_pk_add_f32 v[208:209], v[208:209], v[212:213]
    v_pk_add_f32 v[210:211], v[210:211], v[214:215]
    s_waitcnt lgkmcnt(0)
    v_fma_f32 v208, -v224, v244, v208
    v_fma_f32 v209, -v225, v244, v209
    v_fma_f32 v210, -v226, v244, v210
    v_fma_f32 v211, -v227, v244, v211
    v_mul_f32 v208, v208, v220
    v_mul_f32 v209, v209, v221
    v_mul_f32 v210, v210, v222
    v_mul_f32 v211, v211, v223
KVST_53:
    v_cvt_pk_bf16_f32 v212, v208, v209
    v_cvt_pk_bf16_f32 v213, v210, v211
    buffer_store_dwordx2 v[212:213], v7, s[8:11], s31 offen sc1
    s_setprio 0
NOKV_51:
    s_cmp_eq_u32 s48, 0
    s_cbranch_scc1 NOKVF_57
    s_lshl_b32 s30, s19, 8
    s_add_u32 s30, s30, 7421952
    s_add_u32 s31, s17, 1
    v_mov_b32 v4, s31
    v_mov_b32 v3, s30
    v_mov_b32 v5, 139264
    v_mov_b32 v6, 1
    s_mov_b64 exec, 1
    s_waitcnt vmcnt(0)
    ds_add_rtn_u32 v6, v5, v6
    s_waitcnt lgkmcnt(0)
    v_cmp_eq_u32 vcc, 3, v6
    s_nop 0
    s_and_b64 exec, exec, vcc
    s_cbranch_execz KVNL_58
    buffer_store_dword v4, v3, s[8:11], 0 offen sc1
KVNL_58:
    s_mov_b64 exec, -1
NOKVF_57:
    s_lshl_b32 s42, s20, 3
    s_add_u32 s42, s42, s3
    s_lshl_b32 s42, s42, 14
    buffer_load_dwordx4 v[24:27], v1, s[8:11], s42 offen offset:0
    buffer_load_dwordx4 v[28:31], v1, s[8:11], s42 offen offset:1024
    buffer_load_dwordx4 v[40:43], v1, s[8:11], s42 offen offset:2048
    buffer_load_dwordx4 v[44:47], v1, s[8:11], s42 offen offset:3072
    s_add_u32 s42, s42, 4096
    buffer_load_dwordx4 v[48:51], v1, s[8:11], s42 offen offset:0
    ds_read_b128 v[132:135], v1 offset:0
    ds_read_b128 v[136:139], v1 offset:16384
    ds_read_b128 v[140:143], v1 offset:1024
    ds_read_b128 v[144:147], v1 offset:17408
    ds_read_b128 v[148:151], v1 offset:2048
    ds_read_b128 v[152:155], v1 offset:18432
    ds_read_b128 v[156:159], v1 offset:3072
    ds_read_b128 v[160:163], v1 offset:19456
    v_mul_f32 v232, 1052289595, v232
    v_mul_f32 v233, 1052289595, v233
    s_waitcnt vmcnt(4) lgkmcnt(6)
    v_mfma_f32_16x16x32_bf16 v[196:199], v[24:27], v[132:135], 0
    v_mfma_f32_16x16x32_bf16 v[200:203], v[24:27], v[136:139], 0
    buffer_load_dwordx4 v[52:55], v1, s[8:11], s42 offen offset:1024
    ds_read_b128 v[132:135], v1 offset:4096
    ds_read_b128 v[136:139], v1 offset:20480
    s_waitcnt vmcnt(4) lgkmcnt(6)
    v_mfma_f32_16x16x32_bf16 v[196:199], v[28:31], v[140:143], v[196:199]
    v_mfma_f32_16x16x32_bf16 v[200:203], v[28:31], v[144:147], v[200:203]
    buffer_load_dwordx4 v[56:59], v1, s[8:11], s42 offen offset:2048
    ds_read_b128 v[140:143], v1 offset:5120
    ds_read_b128 v[144:147], v1 offset:21504
    s_waitcnt vmcnt(4) lgkmcnt(6)
    v_mfma_f32_16x16x32_bf16 v[196:199], v[40:43], v[148:151], v[196:199]
    v_mfma_f32_16x16x32_bf16 v[200:203], v[40:43], v[152:155], v[200:203]
    buffer_load_dwordx4 v[60:63], v1, s[8:11], s42 offen offset:3072
    ds_read_b128 v[148:151], v1 offset:6144
    ds_read_b128 v[152:155], v1 offset:22528
    s_waitcnt vmcnt(4) lgkmcnt(6)
    v_mfma_f32_16x16x32_bf16 v[196:199], v[44:47], v[156:159], v[196:199]
    v_mfma_f32_16x16x32_bf16 v[200:203], v[44:47], v[160:163], v[200:203]
    s_add_u32 s42, s42, 4096
    buffer_load_dwordx4 v[164:167], v1, s[8:11], s42 offen offset:0
    ds_read_b128 v[156:159], v1 offset:7168
    ds_read_b128 v[160:163], v1 offset:23552
    s_waitcnt vmcnt(4) lgkmcnt(6)
    v_mfma_f32_16x16x32_bf16 v[196:199], v[48:51], v[132:135], v[196:199]
    v_mfma_f32_16x16x32_bf16 v[200:203], v[48:51], v[136:139], v[200:203]
    buffer_load_dwordx4 v[168:171], v1, s[8:11], s42 offen offset:1024
    ds_read_b128 v[132:135], v1 offset:8192
    ds_read_b128 v[136:139], v1 offset:24576
    s_waitcnt vmcnt(4) lgkmcnt(6)
    v_mfma_f32_16x16x32_bf16 v[196:199], v[52:55], v[140:143], v[196:199]
    v_mfma_f32_16x16x32_bf16 v[200:203], v[52:55], v[144:147], v[200:203]
    buffer_load_dwordx4 v[172:175], v1, s[8:11], s42 offen offset:2048
    ds_read_b128 v[140:143], v1 offset:9216
    ds_read_b128 v[144:147], v1 offset:25600
    s_waitcnt vmcnt(4) lgkmcnt(6)
    v_mfma_f32_16x16x32_bf16 v[196:199], v[56:59], v[148:151], v[196:199]
    v_mfma_f32_16x16x32_bf16 v[200:203], v[56:59], v[152:155], v[200:203]
    buffer_load_dwordx4 v[176:179], v1, s[8:11], s42 offen offset:3072
    ds_read_b128 v[148:151], v1 offset:10240
    ds_read_b128 v[152:155], v1 offset:26624
    s_waitcnt vmcnt(4) lgkmcnt(6)
    v_mfma_f32_16x16x32_bf16 v[196:199], v[60:63], v[156:159], v[196:199]
    v_mfma_f32_16x16x32_bf16 v[200:203], v[60:63], v[160:163], v[200:203]
    s_add_u32 s42, s42, 4096
    buffer_load_dwordx4 v[180:183], v1, s[8:11], s42 offen offset:0
    ds_read_b128 v[156:159], v1 offset:11264
    ds_read_b128 v[160:163], v1 offset:27648
    s_waitcnt vmcnt(4) lgkmcnt(6)
    v_mfma_f32_16x16x32_bf16 v[196:199], v[164:167], v[132:135], v[196:199]
    v_mfma_f32_16x16x32_bf16 v[200:203], v[164:167], v[136:139], v[200:203]
    buffer_load_dwordx4 v[184:187], v1, s[8:11], s42 offen offset:1024
    ds_read_b128 v[132:135], v1 offset:12288
    ds_read_b128 v[136:139], v1 offset:28672
    s_waitcnt vmcnt(4) lgkmcnt(6)
    v_mfma_f32_16x16x32_bf16 v[196:199], v[168:171], v[140:143], v[196:199]
    v_mfma_f32_16x16x32_bf16 v[200:203], v[168:171], v[144:147], v[200:203]
    buffer_load_dwordx4 v[188:191], v1, s[8:11], s42 offen offset:2048
    ds_read_b128 v[140:143], v1 offset:13312
    ds_read_b128 v[144:147], v1 offset:29696
    s_waitcnt vmcnt(4) lgkmcnt(6)
    v_mfma_f32_16x16x32_bf16 v[196:199], v[172:175], v[148:151], v[196:199]
    v_mfma_f32_16x16x32_bf16 v[200:203], v[172:175], v[152:155], v[200:203]
    buffer_load_dwordx4 v[192:195], v1, s[8:11], s42 offen offset:3072
    ds_read_b128 v[148:151], v1 offset:14336
    ds_read_b128 v[152:155], v1 offset:30720
    s_waitcnt vmcnt(4) lgkmcnt(6)
    v_mfma_f32_16x16x32_bf16 v[196:199], v[176:179], v[156:159], v[196:199]
    v_mfma_f32_16x16x32_bf16 v[200:203], v[176:179], v[160:163], v[200:203]
    ds_read_b128 v[156:159], v1 offset:15360
    ds_read_b128 v[160:163], v1 offset:31744
    s_waitcnt vmcnt(3) lgkmcnt(6)
    v_mfma_f32_16x16x32_bf16 v[196:199], v[180:183], v[132:135], v[196:199]
    v_mfma_f32_16x16x32_bf16 v[200:203], v[180:183], v[136:139], v[200:203]
    v_bfe_u32 v248, v0, 1, 2
    v_lshlrev_b32 v248, 4, v248
    v_and_b32 v249, 1, v0
    v_add_u32 v248, v248, v249
    s_lshl_b32 s30, s3, 1
    v_add_u32 v248, s30, v248
    v_lshlrev_b32 v248, 8, v248
    v_add_u32 v248, 7421952, v248
    s_mov_b32 s47, 2
    s_mov_b32 s45, 0
    buffer_load_dword v251, v248, s[8:11], 0 offen sc1
    s_waitcnt vmcnt(2) lgkmcnt(4)
    v_mfma_f32_16x16x32_bf16 v[196:199], v[184:187], v[140:143], v[196:199]
    v_mfma_f32_16x16x32_bf16 v[200:203], v[184:187], v[144:147], v[200:203]
    s_waitcnt vmcnt(1) lgkmcnt(2)
    v_mfma_f32_16x16x32_bf16 v[196:199], v[188:191], v[148:151], v[196:199]
    v_mfma_f32_16x16x32_bf16 v[200:203], v[188:191], v[152:155], v[200:203]
    s_waitcnt vmcnt(0) lgkmcnt(0)
    v_mfma_f32_16x16x32_bf16 v[196:199], v[192:195], v[156:159], v[196:199]
    v_mfma_f32_16x16x32_bf16 v[200:203], v[192:195], v[160:163], v[200:203]
    v_cmp_gt_u32 vcc, s47, v251
    s_cbranch_vccnz KVNY_59
    s_lshl_b32 s33, s3, 12
    s_add_u32 m0, s33, 32768
    s_add_u32 s31, s33, s49
    buffer_load_dwordx4 v1, s[8:11], s31 offen offset:0 sc1 lds
    buffer_load_dwordx4 v1, s[8:11], s31 offen offset:1024 sc1 lds
    buffer_load_dwordx4 v1, s[8:11], s31 offen offset:2048 sc1 lds
    buffer_load_dwordx4 v1, s[8:11], s31 offen offset:3072 sc1 lds
    s_mov_b32 s45, 1
KVNY_59:
    s_nop 7
    v_fma_f32 v196, -v234, v204, v196
    v_fma_f32 v197, -v234, v205, v197
    v_fma_f32 v198, -v234, v206, v198
    v_fma_f32 v199, -v234, v207, v199
    v_fma_f32 v200, -v235, v204, v200
    v_fma_f32 v201, -v235, v205, v201
    v_fma_f32 v202, -v235, v206, v202
    v_fma_f32 v203, -v235, v207, v203
    s_cmp_eq_u32 s45, 1
    s_cbranch_scc1 KVDONE_60
    s_mov_b32 s46, 262144
POLL_61:
    buffer_load_dword v251, v248, s[8:11], 0 offen sc1
    s_waitcnt vmcnt(0)
    v_cmp_gt_u32 vcc, s47, v251
    s_cbranch_vccz POLLD_62
    s_sub_u32 s46, s46, 1
    s_cbranch_scc0 POLL_61
POLLD_62:
    s_lshl_b32 s33, s3, 12
    s_add_u32 m0, s33, 32768
    s_add_u32 s31, s33, s49
    buffer_load_dwordx4 v1, s[8:11], s31 offen offset:0 sc1 lds
    buffer_load_dwordx4 v1, s[8:11], s31 offen offset:1024 sc1 lds
    buffer_load_dwordx4 v1, s[8:11], s31 offen offset:2048 sc1 lds
    buffer_load_dwordx4 v1, s[8:11], s31 offen offset:3072 sc1 lds
KVDONE_60:
M_ATTN:
    s_lshl_b32 s30, s3, 10
    s_add_u32 s30, s30, 114688
    v_add_u32 v132, s30, v1
    v_mul_f32 v196, v196, v232
    v_mul_f32 v197, v197, v232
    v_mul_f32 v198, v198, v232
    v_mul_f32 v199, v199, v232
    v_mul_f32 v200, v200, v233
    v_mul_f32 v201, v201, v233
    v_mul_f32 v202, v202, v233
    v_mul_f32 v203, v203, v233
    v_cvt_pk_bf16_f32 v128, v196, v197
    v_cvt_pk_bf16_f32 v129, v198, v199
    v_cvt_pk_bf16_f32 v130, v200, v201
    v_cvt_pk_bf16_f32 v131, v202, v203
    s_nop 1
    v_permlane16_swap_b32 v128, v130
    v_permlane16_swap_b32 v129, v131
    ds_write_b128 v132, v[128:131]
    s_add_u32 s30, s33, 32768
    v_mov_b32 v216, 0
    v_mov_b32 v217, 0
    v_mov_b32 v218, 0
    v_mov_b32 v219, 0
    v_and_b32 v3, 27, v0
    v_cmp_eq_u32 vcc, 16, v3
    v_mov_b32 v3, s27
    v_mfma_f32_32x32x16_bf16 v[184:199], v[216:219], v[216:219], 0
    v_mfma_f32_32x32x16_bf16 v[200:215], v[216:219], v[216:219], 0
    v_cndmask_b32 v2, 0, v3, vcc
    v_cndmask_b32 v3, 0, v3, vcc
    v_pk_mov_b32 v[224:225], v[2:3], v[2:3]
    v_pk_mov_b32 v[226:227], v[2:3], v[2:3]
    v_pk_mov_b32 v[228:229], v[2:3], v[2:3]
    v_pk_mov_b32 v[230:231], v[2:3], v[2:3]
    v_pk_mov_b32 v[232:233], v[2:3], v[2:3]
    v_pk_mov_b32 v[234:235], v[2:3], v[2:3]
    v_pk_mov_b32 v[236:237], v[2:3], v[2:3]
    v_pk_mov_b32 v[238:239], v[2:3], v[2:3]
    v_mov_b32 v252, 0xdddddddd
    s_and_b32 s45, s3, 1
    s_lshl_b32 s32, s45, 11
    s_add_u32 s32, s32, 32768
    v_add_u32 v253, s32, v1
    v_add_u32 v254, 65536, v253
    s_and_b32 s32, s3, 6
    s_lshl_b32 s32, s32, 10
    s_add_u32 s32, s32, 114688
    v_add_u32 v4, s32, v1
    s_lshl_b32 s42, s19, 8
    s_lshl_b32 s46, s20, 2
    s_add_u32 s42, s42, s46
    s_add_u32 s42, s42, 7422080
    s_lshl_b32 s46, s16, 2
    s_add_u32 s46, s46, 7413760
    s_cmp_eq_u32 s3, 6
    s_cselect_b32 s42, s46, s42
    s_cselect_b32 s46, s50, 1
    v_mov_b32 v248, s42
    v_mov_b32 v249, s46
    v_and_b32 v250, 7, v0
    s_lshl_b32 s42, s3, 3
    v_add_u32 v250, s42, v250
    v_lshlrev_b32 v250, 8, v250
    v_add_u32 v250, 7422080, v250
    s_cmp_eq_u32 s3, 0
    s_cselect_b32 s94, 1, 0
    s_cmp_eq_u32 s3, 6
    s_cselect_b32 s94, 1, s94
    s_mov_b32 s95, 0
    s_cmp_eq_u32 s17, 0
    s_cselect_b64 s[90:91], -1, 0
    s_cselect_b32 s94, s94, 0
    s_waitcnt vmcnt(0)
    s_waitcnt lgkmcnt(0)
    s_barrier
    ds_read_b128 v[240:243], v4
    ds_read_b128 v[216:219], v253 offset:0
    ds_read_b128 v[244:247], v4 offset:1024
    ds_read_b128 v[220:223], v253 offset:4096
    s_mov_b64 exec, s[28:29]
    ds_read_b128 v[224:227], v253 offset:1024
    ds_read_b128 v[228:231], v253 offset:1280
    s_mov_b64 exec, -1
    s_waitcnt lgkmcnt(4)
    v_mfma_f32_32x32x16_bf16 v[152:167], v[216:219], v[240:243], 0
    s_waitcnt lgkmcnt(0)
    s_setprio 3
    s_nop 9
    v_exp_f32 v152, v152
    v_exp_f32 v153, v153
    s_mov_b64 exec, s[28:29]
    ds_read_b128 v[232:235], v253 offset:5120
    ds_read_b128 v[236:239], v253 offset:5376
    s_mov_b64 exec, -1
    v_exp_f32 v154, v154
    v_exp_f32 v155, v155
    v_exp_f32 v156, v156
    v_exp_f32 v157, v157
    v_mfma_f32_32x32x16_bf16 v[168:183], v[216:219], v[244:247], 0
    ds_read_b128 v[216:219], v253 offset:8192
    v_exp_f32 v158, v158
    v_exp_f32 v159, v159
    v_exp_f32 v160, v160
    v_exp_f32 v161, v161
    v_exp_f32 v162, v162
    v_smfmac_f32_32x32x32_bf16 v[184:199], v[224:227], v[152:159], v252
    s_add_u32 m0, s30, 32768
    s_add_u32 s32, s31, 32768
    buffer_load_dwordx4 v1, s[8:11], s32 offen offset:0 sc1 lds
    s_mov_b64 exec, s[94:95]
    buffer_store_dword v249, v248, s[8:11], 0 offen sc1
    s_mov_b64 exec, -1
    s_mul_i32 s34, s23, 114688
    s_add_u32 s34, s34, 1114112
    s_lshl_b32 s35, s20, 2
    s_lshr_b32 s36, s3, 1
    s_add_u32 s35, s35, s36
    v_exp_f32 v163, v163
    v_exp_f32 v164, v164
    v_exp_f32 v165, v165
    v_exp_f32 v166, v166
    v_exp_f32 v167, v167
    v_exp_f32 v168, v168
    v_exp_f32 v169, v169
    v_smfmac_f32_32x32x32_bf16 v[184:199], v[228:231], v[160:167], v252
    v_exp_f32 v170, v170
    v_exp_f32 v171, v171
    v_exp_f32 v172, v172
    v_exp_f32 v173, v173
    v_mfma_f32_32x32x16_bf16 v[152:167], v[220:223], v[240:243], 0
    v_exp_f32 v174, v174
    v_exp_f32 v175, v175
    v_exp_f32 v176, v176
    v_exp_f32 v177, v177
    v_exp_f32 v178, v178
    v_smfmac_f32_32x32x32_bf16 v[200:215], v[224:227], v[168:175], v252
    buffer_load_dwordx4 v1, s[8:11], s32 offen offset:1024 sc1 lds
    s_lshl_b32 s36, s20, 3
    s_add_u32 s36, s36, s3
    s_lshl_b32 s36, s36, 14
    s_add_u32 s36, s36, 589824
    s_lshl_b32 s38, s19, 5
    s_add_u32 s38, s38, s35
    v_exp_f32 v179, v179
    v_exp_f32 v180, v180
    v_exp_f32 v181, v181
    v_exp_f32 v182, v182
    v_exp_f32 v183, v183
    s_waitcnt lgkmcnt(0)
    s_setprio 2
    v_exp_f32 v152, v152
    v_exp_f32 v153, v153
    v_smfmac_f32_32x32x32_bf16 v[200:215], v[228:231], v[176:183], v252
    s_mov_b64 exec, s[28:29]
    ds_read_b128 v[224:227], v253 offset:9216
    ds_read_b128 v[228:231], v253 offset:9472
    s_mov_b64 exec, -1
    v_exp_f32 v154, v154
    v_exp_f32 v155, v155
    v_exp_f32 v156, v156
    v_exp_f32 v157, v157
    v_mfma_f32_32x32x16_bf16 v[168:183], v[220:223], v[244:247], 0
    ds_read_b128 v[220:223], v253 offset:12288
    v_exp_f32 v158, v158
    v_exp_f32 v159, v159
    v_exp_f32 v160, v160
    v_exp_f32 v161, v161
    v_exp_f32 v162, v162
    v_smfmac_f32_32x32x32_bf16 v[184:199], v[232:235], v[152:159], v252
    buffer_load_dwordx4 v1, s[8:11], s32 offen offset:2048 sc1 lds
    s_lshl_b32 s38, s38, 10
    s_lshl_b32 s37, s45, 9
    s_add_u32 s37, s37, s38
    s_lshl_b32 s39, s19, 15
    s_lshl_b32 s42, s35, 6
    s_add_u32 s39, s39, s42
    v_exp_f32 v163, v163
    v_exp_f32 v164, v164
    v_exp_f32 v165, v165
    v_exp_f32 v166, v166
    v_exp_f32 v167, v167
    v_exp_f32 v168, v168
    v_exp_f32 v169, v169
    v_smfmac_f32_32x32x32_bf16 v[184:199], v[236:239], v[160:167], v252
    v_exp_f32 v170, v170
    v_exp_f32 v171, v171
    v_exp_f32 v172, v172
    v_exp_f32 v173, v173
    v_mfma_f32_32x32x16_bf16 v[152:167], v[216:219], v[240:243], 0
    v_exp_f32 v174, v174
    v_exp_f32 v175, v175
    v_exp_f32 v176, v176
    v_exp_f32 v177, v177
    v_exp_f32 v178, v178
    v_smfmac_f32_32x32x32_bf16 v[200:215], v[232:235], v[168:175], v252
    buffer_load_dwordx4 v1, s[8:11], s32 offen offset:3072 sc1 lds
    s_lshl_b32 s42, s45, 5
    s_add_u32 s39, s39, s42
    v_bfe_u32 v255, v0, 4, 1
    v_lshlrev_b32 v255, 14, v255
    v_lshrrev_b32 v3, 5, v0
    v_lshl_add_u32 v255, v3, 8, v255
    v_exp_f32 v179, v179
    v_exp_f32 v180, v180
    v_exp_f32 v181, v181
    v_exp_f32 v182, v182
    v_exp_f32 v183, v183
    s_waitcnt lgkmcnt(0)
    v_exp_f32 v152, v152
    v_exp_f32 v153, v153
    v_smfmac_f32_32x32x32_bf16 v[200:215], v[236:239], v[176:183], v252
    s_mov_b64 exec, s[28:29]
    ds_read_b128 v[232:235], v253 offset:13312
    ds_read_b128 v[236:239], v253 offset:13568
    s_mov_b64 exec, -1
    v_exp_f32 v154, v154
    v_exp_f32 v155, v155
    v_exp_f32 v156, v156
    v_exp_f32 v157, v157
    v_mfma_f32_32x32x16_bf16 v[168:183], v[216:219], v[244:247], 0
    ds_read_b128 v[216:219], v253 offset:16384
    v_exp_f32 v158, v158
    v_exp_f32 v159, v159
    v_exp_f32 v160, v160
    v_exp_f32 v161, v161
    v_exp_f32 v162, v162
    v_smfmac_f32_32x32x32_bf16 v[184:199], v[224:227], v[152:159], v252
    s_add_u32 m0, s30, 98304
    s_add_u32 s32, s31, 98304
    buffer_load_dwordx4 v1, s[8:11], s32 offen offset:0 sc1 lds
    v_and_b32 v251, 15, v0
    v_lshl_add_u32 v251, v251, 4, v255
    v_and_b32 v255, 31, v0
    v_lshlrev_b32 v255, 10, v255
    v_lshl_add_u32 v255, v3, 4, v255
    s_add_u32 s42, s37, 8388608
    v_exp_f32 v163, v163
    v_exp_f32 v164, v164
    v_exp_f32 v165, v165
    v_exp_f32 v166, v166
    v_exp_f32 v167, v167
    v_exp_f32 v168, v168
    v_exp_f32 v169, v169
    v_smfmac_f32_32x32x32_bf16 v[184:199], v[228:231], v[160:167], v252
    v_exp_f32 v170, v170
    v_exp_f32 v171, v171
    v_exp_f32 v172, v172
    v_exp_f32 v173, v173
    v_mfma_f32_32x32x16_bf16 v[152:167], v[220:223], v[240:243], 0
    v_exp_f32 v174, v174
    v_exp_f32 v175, v175
    v_exp_f32 v176, v176
    v_exp_f32 v177, v177
    v_exp_f32 v178, v178
    v_smfmac_f32_32x32x32_bf16 v[200:215], v[224:227], v[168:175], v252
    buffer_load_dwordx4 v1, s[8:11], s32 offen offset:1024 sc1 lds
    s_cmp_eq_u32 s17, 0
    s_cselect_b32 s39, s39, s42
    s_cselect_b64 vcc, -1, 0
    v_cndmask_b32 v255, v251, v255, vcc
    s_mul_i32 s40, s3, 7168
    s_mul_i32 s41, s3, 3072
    v_exp_f32 v179, v179
    v_exp_f32 v180, v180
    v_exp_f32 v181, v181
    v_exp_f32 v182, v182
    v_exp_f32 v183, v183
    s_waitcnt lgkmcnt(0)
    s_setprio 1
    v_exp_f32 v152, v152
    v_exp_f32 v153, v153
    v_smfmac_f32_32x32x32_bf16 v[200:215], v[228:231], v[176:183], v252
    s_mov_b64 exec, s[28:29]
    ds_read_b128 v[224:227], v253 offset:17408
    ds_read_b128 v[228:231], v253 offset:17664
    s_mov_b64 exec, -1
    v_exp_f32 v154, v154
    v_exp_f32 v155, v155
    v_exp_f32 v156, v156
    v_exp_f32 v157, v157
    v_mfma_f32_32x32x16_bf16 v[168:183], v[220:223], v[244:247], 0
    ds_read_b128 v[220:223], v253 offset:20480
    v_exp_f32 v158, v158
    v_exp_f32 v159, v159
    v_exp_f32 v160, v160
    v_exp_f32 v161, v161
    v_exp_f32 v162, v162
    v_smfmac_f32_32x32x32_bf16 v[184:199], v[232:235], v[152:159], v252
    buffer_load_dwordx4 v1, s[8:11], s32 offen offset:2048 sc1 lds
    s_lshl_b32 s44, s22, 3
    s_add_u32 s44, s44, s3
    s_mul_i32 s44, s44, 28672
    s_add_u32 s44, s44, 4784128
    v_and_b32 v2, 31, v0
    v_exp_f32 v163, v163
    v_exp_f32 v164, v164
    v_exp_f32 v165, v165
    v_exp_f32 v166, v166
    v_exp_f32 v167, v167
    v_exp_f32 v168, v168
    v_exp_f32 v169, v169
    v_smfmac_f32_32x32x32_bf16 v[184:199], v[236:239], v[160:167], v252
    v_exp_f32 v170, v170
    v_exp_f32 v171, v171
    v_exp_f32 v172, v172
    v_exp_f32 v173, v173
    v_mfma_f32_32x32x16_bf16 v[152:167], v[216:219], v[240:243], 0
    v_exp_f32 v174, v174
    v_exp_f32 v175, v175
    v_exp_f32 v176, v176
    v_exp_f32 v177, v177
    v_exp_f32 v178, v178
    v_smfmac_f32_32x32x32_bf16 v[200:215], v[232:235], v[168:175], v252
    buffer_load_dwordx4 v1, s[8:11], s32 offen offset:3072 sc1 lds
    s_lshl_b32 s42, s24, 7
    s_add_u32 s42, s42, 7413760
    v_lshl_add_u32 v2, v2, 2, s42
    s_lshl_b32 s46, s23, 3
    s_add_u32 s46, s46, s3
    s_mul_i32 s84, s24, 917504
    v_exp_f32 v179, v179
    v_exp_f32 v180, v180
    v_exp_f32 v181, v181
    v_exp_f32 v182, v182
    v_exp_f32 v183, v183
    s_waitcnt lgkmcnt(0)
    s_setprio 0
    v_exp_f32 v152, v152
    v_exp_f32 v153, v153
    v_smfmac_f32_32x32x32_bf16 v[200:215], v[236:239], v[176:183], v252
    s_mov_b64 exec, s[28:29]
    ds_read_b128 v[232:235], v253 offset:21504
    ds_read_b128 v[236:239], v253 offset:21760
    s_mov_b64 exec, -1
    v_exp_f32 v154, v154
    v_exp_f32 v155, v155
    v_exp_f32 v156, v156
    v_exp_f32 v157, v157
    v_mfma_f32_32x32x16_bf16 v[168:183], v[216:219], v[244:247], 0
    ds_read_b128 v[216:219], v253 offset:24576
    v_exp_f32 v158, v158
    v_exp_f32 v159, v159
    v_exp_f32 v160, v160
    v_exp_f32 v161, v161
    v_exp_f32 v162, v162
    v_smfmac_f32_32x32x32_bf16 v[184:199], v[224:227], v[152:159], v252
    s_mul_i32 s42, s46, 3584
    s_add_u32 s84, s84, s42
    s_add_u32 s84, s84, 14680064
    s_lshl_b32 s85, s24, 18
    s_lshl_b32 s42, s46, 10
    s_add_u32 s85, s85, s42
    v_exp_f32 v163, v163
    v_exp_f32 v164, v164
    v_exp_f32 v165, v165
    v_exp_f32 v166, v166
    v_exp_f32 v167, v167
    v_exp_f32 v168, v168
    v_exp_f32 v169, v169
    v_smfmac_f32_32x32x32_bf16 v[184:199], v[228:231], v[160:167], v252
    v_exp_f32 v170, v170
    v_exp_f32 v171, v171
    v_exp_f32 v172, v172
    v_exp_f32 v173, v173
    v_mfma_f32_32x32x16_bf16 v[152:167], v[220:223], v[240:243], 0
    v_exp_f32 v174, v174
    v_exp_f32 v175, v175
    v_exp_f32 v176, v176
    v_exp_f32 v177, v177
    v_exp_f32 v178, v178
    v_smfmac_f32_32x32x32_bf16 v[200:215], v[224:227], v[168:175], v252
    s_mov_b64 exec, s[90:91]
    buffer_load_dwordx4 v[8:11], v250, s[8:11], 0 offen sc1
    s_mov_b64 exec, -1
    s_add_u32 s86, s85, 12582912
    s_add_u32 s85, s85, 10485760
    s_lshl_b32 s87, s23, 14
    s_lshl_b32 s42, s24, 11
    s_add_u32 s87, s87, s42
    s_and_b32 s42, s3, 1
    v_exp_f32 v179, v179
    v_exp_f32 v180, v180
    v_exp_f32 v181, v181
    v_exp_f32 v182, v182
    v_exp_f32 v183, v183
    s_waitcnt lgkmcnt(0)
    v_exp_f32 v152, v152
    v_exp_f32 v153, v153
    v_smfmac_f32_32x32x32_bf16 v[200:215], v[228:231], v[176:183], v252
    s_mov_b64 exec, s[28:29]
    ds_read_b128 v[224:227], v253 offset:25600
    ds_read_b128 v[228:231], v253 offset:25856
    s_mov_b64 exec, -1
    v_exp_f32 v154, v154
    v_exp_f32 v155, v155
    v_exp_f32 v156, v156
    v_exp_f32 v157, v157
    v_mfma_f32_32x32x16_bf16 v[168:183], v[220:223], v[244:247], 0
    ds_read_b128 v[220:223], v253 offset:28672
    v_exp_f32 v158, v158
    v_exp_f32 v159, v159
    v_exp_f32 v160, v160
    v_exp_f32 v161, v161
    v_exp_f32 v162, v162
    v_smfmac_f32_32x32x32_bf16 v[184:199], v[232:235], v[152:159], v252
    s_lshl_b32 s42, s42, 10
    s_add_u32 s87, s87, s42
    s_add_u32 s87, s87, 7864320
    s_add_u32 s88, s85, 4292870144
    s_and_b32 s89, s23, 15
    s_lshl_b32 s89, s89, 14
    v_exp_f32 v163, v163
    v_exp_f32 v164, v164
    v_exp_f32 v165, v165
    v_exp_f32 v166, v166
    v_exp_f32 v167, v167
    v_exp_f32 v168, v168
    v_exp_f32 v169, v169
    v_smfmac_f32_32x32x32_bf16 v[184:199], v[236:239], v[160:167], v252
    v_exp_f32 v170, v170
    v_exp_f32 v171, v171
    v_exp_f32 v172, v172
    v_exp_f32 v173, v173
    v_mfma_f32_32x32x16_bf16 v[152:167], v[216:219], v[240:243], 0
    v_exp_f32 v174, v174
    v_exp_f32 v175, v175
    v_exp_f32 v176, v176
    v_exp_f32 v177, v177
    v_exp_f32 v178, v178
    v_smfmac_f32_32x32x32_bf16 v[200:215], v[232:235], v[168:175], v252
    s_lshl_b32 s42, s24, 11
    s_add_u32 s89, s89, s42
    s_and_b32 s42, s3, 1
    s_lshl_b32 s42, s42, 10
    s_add_u32 s89, s89, s42
    s_add_u32 s89, s89, 6881280
    v_exp_f32 v179, v179
    v_exp_f32 v180, v180
    v_exp_f32 v181, v181
    v_exp_f32 v182, v182
    v_exp_f32 v183, v183
    s_waitcnt vmcnt(4) lgkmcnt(0)
    s_cmp_eq_u32 s17, 0
    s_cbranch_scc0 M_UWAIT_BACK
    s_waitcnt vmcnt(0)
    v_min3_u32 v8, v8, v9, v10
    v_min_u32 v8, v8, v11
    v_cmp_eq_u32 vcc, 0, v8
    s_cbranch_vccnz M_UWAIT
M_UWAIT_BACK:
    s_barrier
    s_setprio 3
    v_exp_f32 v152, v152
    v_exp_f32 v153, v153
    v_smfmac_f32_32x32x32_bf16 v[200:215], v[236:239], v[176:183], v252
    s_mov_b64 exec, s[28:29]
    ds_read_b128 v[232:235], v253 offset:29696
    ds_read_b128 v[236:239], v253 offset:29952
    s_mov_b64 exec, -1
    v_exp_f32 v154, v154
    v_exp_f32 v155, v155
    v_exp_f32 v156, v156
    v_exp_f32 v157, v157
    v_mfma_f32_32x32x16_bf16 v[168:183], v[216:219], v[244:247], 0
    ds_read_b128 v[216:219], v253 offset:32768
    v_exp_f32 v158, v158
    v_exp_f32 v159, v159
    v_exp_f32 v160, v160
    v_exp_f32 v161, v161
    v_exp_f32 v162, v162
    v_smfmac_f32_32x32x32_bf16 v[184:199], v[224:227], v[152:159], v252
    s_add_u32 m0, s30, 65536
    s_add_u32 s32, s31, 65536
    buffer_load_dwordx4 v1, s[8:11], s32 offen offset:0 sc1 lds
    v_exp_f32 v163, v163
    v_exp_f32 v164, v164
    v_exp_f32 v165, v165
    v_exp_f32 v166, v166
    v_exp_f32 v167, v167
    v_exp_f32 v168, v168
    v_exp_f32 v169, v169
    v_smfmac_f32_32x32x32_bf16 v[184:199], v[228:231], v[160:167], v252
    v_exp_f32 v170, v170
    v_exp_f32 v171, v171
    v_exp_f32 v172, v172
    v_exp_f32 v173, v173
    v_mfma_f32_32x32x16_bf16 v[152:167], v[220:223], v[240:243], 0
    v_exp_f32 v174, v174
    v_exp_f32 v175, v175
    v_exp_f32 v176, v176
    v_exp_f32 v177, v177
    v_exp_f32 v178, v178
    v_smfmac_f32_32x32x32_bf16 v[200:215], v[224:227], v[168:175], v252
    s_mov_b64 exec, s[90:91]
    buffer_load_dwordx4 v[148:151], v1, s[8:11], s85 offen offset:0
    s_mov_b64 exec, -1
    buffer_load_dwordx4 v1, s[8:11], s32 offen offset:1024 sc1 lds
    v_exp_f32 v179, v179
    v_exp_f32 v180, v180
    v_exp_f32 v181, v181
    v_exp_f32 v182, v182
    v_exp_f32 v183, v183
    s_waitcnt lgkmcnt(0)
    v_exp_f32 v152, v152
    v_exp_f32 v153, v153
    v_smfmac_f32_32x32x32_bf16 v[200:215], v[228:231], v[176:183], v252
    s_mov_b64 exec, s[28:29]
    ds_read_b128 v[224:227], v253 offset:33792
    ds_read_b128 v[228:231], v253 offset:34048
    s_mov_b64 exec, -1
    v_exp_f32 v154, v154
    v_exp_f32 v155, v155
    v_exp_f32 v156, v156
    v_exp_f32 v157, v157
    v_mfma_f32_32x32x16_bf16 v[168:183], v[220:223], v[244:247], 0
    ds_read_b128 v[220:223], v253 offset:36864
    v_exp_f32 v158, v158
    v_exp_f32 v159, v159
    v_exp_f32 v160, v160
    v_exp_f32 v161, v161
    v_exp_f32 v162, v162
    v_smfmac_f32_32x32x32_bf16 v[184:199], v[232:235], v[152:159], v252
    buffer_load_dwordx4 v1, s[8:11], s32 offen offset:2048 sc1 lds
    v_exp_f32 v163, v163
    v_exp_f32 v164, v164
    v_exp_f32 v165, v165
    v_exp_f32 v166, v166
    v_exp_f32 v167, v167
    v_exp_f32 v168, v168
    v_exp_f32 v169, v169
    v_smfmac_f32_32x32x32_bf16 v[184:199], v[236:239], v[160:167], v252
    v_exp_f32 v170, v170
    v_exp_f32 v171, v171
    v_exp_f32 v172, v172
    v_exp_f32 v173, v173
    v_mfma_f32_32x32x16_bf16 v[152:167], v[216:219], v[240:243], 0
    v_exp_f32 v174, v174
    v_exp_f32 v175, v175
    v_exp_f32 v176, v176
    v_exp_f32 v177, v177
    v_exp_f32 v178, v178
    v_smfmac_f32_32x32x32_bf16 v[200:215], v[232:235], v[168:175], v252
    buffer_load_dwordx4 v1, s[8:11], s32 offen offset:3072 sc1 lds
    v_exp_f32 v179, v179
    v_exp_f32 v180, v180
    v_exp_f32 v181, v181
    v_exp_f32 v182, v182
    v_exp_f32 v183, v183
    s_waitcnt lgkmcnt(0)
    s_setprio 2
    v_exp_f32 v152, v152
    v_exp_f32 v153, v153
    v_smfmac_f32_32x32x32_bf16 v[200:215], v[236:239], v[176:183], v252
    s_mov_b64 exec, s[28:29]
    ds_read_b128 v[232:235], v253 offset:37888
    ds_read_b128 v[236:239], v253 offset:38144
    s_mov_b64 exec, -1
    v_exp_f32 v154, v154
    v_exp_f32 v155, v155
    v_exp_f32 v156, v156
    v_exp_f32 v157, v157
    v_mfma_f32_32x32x16_bf16 v[168:183], v[216:219], v[244:247], 0
    ds_read_b128 v[216:219], v253 offset:40960
    v_exp_f32 v158, v158
    v_exp_f32 v159, v159
    v_exp_f32 v160, v160
    v_exp_f32 v161, v161
    v_exp_f32 v162, v162
    v_smfmac_f32_32x32x32_bf16 v[184:199], v[224:227], v[152:159], v252
    s_mov_b32 m0, s33
    s_add_u32 s32, s34, s33
    buffer_load_dwordx4 v1, s[8:11], s32 offen offset:0 lds
    v_exp_f32 v163, v163
    v_exp_f32 v164, v164
    v_exp_f32 v165, v165
    v_exp_f32 v166, v166
    v_exp_f32 v167, v167
    v_exp_f32 v168, v168
    v_exp_f32 v169, v169
    v_smfmac_f32_32x32x32_bf16 v[184:199], v[228:231], v[160:167], v252
    v_exp_f32 v170, v170
    v_exp_f32 v171, v171
    v_exp_f32 v172, v172
    v_exp_f32 v173, v173
    v_mfma_f32_32x32x16_bf16 v[152:167], v[220:223], v[240:243], 0
    v_exp_f32 v174, v174
    v_exp_f32 v175, v175
    v_exp_f32 v176, v176
    v_exp_f32 v177, v177
    v_exp_f32 v178, v178
    v_smfmac_f32_32x32x32_bf16 v[200:215], v[224:227], v[168:175], v252
    buffer_load_dwordx4 v[8:11], v1, s[8:11], s36 offen offset:0
    v_exp_f32 v179, v179
    v_exp_f32 v180, v180
    v_exp_f32 v181, v181
    v_exp_f32 v182, v182
    v_exp_f32 v183, v183
    s_waitcnt lgkmcnt(0)
    v_exp_f32 v152, v152
    v_exp_f32 v153, v153
    v_smfmac_f32_32x32x32_bf16 v[200:215], v[228:231], v[176:183], v252
    s_mov_b64 exec, s[28:29]
    ds_read_b128 v[224:227], v253 offset:41984
    ds_read_b128 v[228:231], v253 offset:42240
    s_mov_b64 exec, -1
    v_exp_f32 v154, v154
    v_exp_f32 v155, v155
    v_exp_f32 v156, v156
    v_exp_f32 v157, v157
    v_mfma_f32_32x32x16_bf16 v[168:183], v[220:223], v[244:247], 0
    ds_read_b128 v[220:223], v253 offset:45056
    v_exp_f32 v158, v158
    v_exp_f32 v159, v159
    v_exp_f32 v160, v160
    v_exp_f32 v161, v161
    v_exp_f32 v162, v162
    v_smfmac_f32_32x32x32_bf16 v[184:199], v[232:235], v[152:159], v252
    buffer_load_dwordx4 v[12:15], v1, s[8:11], s36 offen offset:1024
    buffer_load_dwordx4 v1, s[8:11], s32 offen offset:1024 lds
    v_exp_f32 v163, v163
    v_exp_f32 v164, v164
    v_exp_f32 v165, v165
    v_exp_f32 v166, v166
    v_exp_f32 v167, v167
    v_exp_f32 v168, v168
    v_exp_f32 v169, v169
    v_smfmac_f32_32x32x32_bf16 v[184:199], v[236:239], v[160:167], v252
    v_exp_f32 v170, v170
    v_exp_f32 v171, v171
    v_exp_f32 v172, v172
    v_exp_f32 v173, v173
    v_mfma_f32_32x32x16_bf16 v[152:167], v[216:219], v[240:243], 0
    v_exp_f32 v174, v174
    v_exp_f32 v175, v175
    v_exp_f32 v176, v176
    v_exp_f32 v177, v177
    v_exp_f32 v178, v178
    v_smfmac_f32_32x32x32_bf16 v[200:215], v[232:235], v[168:175], v252
    v_exp_f32 v179, v179
    v_exp_f32 v180, v180
    v_exp_f32 v181, v181
    v_exp_f32 v182, v182
    v_exp_f32 v183, v183
    s_waitcnt lgkmcnt(0)
    s_setprio 1
    v_exp_f32 v152, v152
    v_exp_f32 v153, v153
    v_smfmac_f32_32x32x32_bf16 v[200:215], v[236:239], v[176:183], v252
    s_mov_b64 exec, s[28:29]
    ds_read_b128 v[232:235], v253 offset:46080
    ds_read_b128 v[236:239], v253 offset:46336
    s_mov_b64 exec, -1
    v_exp_f32 v154, v154
    v_exp_f32 v155, v155
    v_exp_f32 v156, v156
    v_exp_f32 v157, v157
    v_mfma_f32_32x32x16_bf16 v[168:183], v[216:219], v[244:247], 0
    ds_read_b128 v[216:219], v253 offset:49152
    v_exp_f32 v158, v158
    v_exp_f32 v159, v159
    v_exp_f32 v160, v160
    v_exp_f32 v161, v161
    v_exp_f32 v162, v162
    v_smfmac_f32_32x32x32_bf16 v[184:199], v[224:227], v[152:159], v252
    buffer_load_dwordx4 v[16:19], v1, s[8:11], s36 offen offset:2048
    v_exp_f32 v163, v163
    v_exp_f32 v164, v164
    v_exp_f32 v165, v165
    v_exp_f32 v166, v166
    v_exp_f32 v167, v167
    v_exp_f32 v168, v168
    v_exp_f32 v169, v169
    v_smfmac_f32_32x32x32_bf16 v[184:199], v[228:231], v[160:167], v252
    v_exp_f32 v170, v170
    v_exp_f32 v171, v171
    v_exp_f32 v172, v172
    v_exp_f32 v173, v173
    v_mfma_f32_32x32x16_bf16 v[152:167], v[220:223], v[240:243], 0
    v_exp_f32 v174, v174
    v_exp_f32 v175, v175
    v_exp_f32 v176, v176
    v_exp_f32 v177, v177
    v_exp_f32 v178, v178
    v_smfmac_f32_32x32x32_bf16 v[200:215], v[224:227], v[168:175], v252
    buffer_load_dwordx4 v[20:23], v1, s[8:11], s36 offen offset:3072
    buffer_load_dwordx4 v1, s[8:11], s32 offen offset:2048 lds
    v_exp_f32 v179, v179
    v_exp_f32 v180, v180
    v_exp_f32 v181, v181
    v_exp_f32 v182, v182
    v_exp_f32 v183, v183
    s_waitcnt lgkmcnt(0)
    v_exp_f32 v152, v152
    v_exp_f32 v153, v153
    v_smfmac_f32_32x32x32_bf16 v[200:215], v[228:231], v[176:183], v252
    s_mov_b64 exec, s[28:29]
    ds_read_b128 v[224:227], v253 offset:50176
    ds_read_b128 v[228:231], v253 offset:50432
    s_mov_b64 exec, -1
    v_exp_f32 v154, v154
    v_exp_f32 v155, v155
    v_exp_f32 v156, v156
    v_exp_f32 v157, v157
    v_mfma_f32_32x32x16_bf16 v[168:183], v[220:223], v[244:247], 0
    ds_read_b128 v[220:223], v253 offset:53248
    v_exp_f32 v158, v158
    v_exp_f32 v159, v159
    v_exp_f32 v160, v160
    v_exp_f32 v161, v161
    v_exp_f32 v162, v162
    v_smfmac_f32_32x32x32_bf16 v[184:199], v[232:235], v[152:159], v252
    s_mov_b64 exec, s[90:91]
    buffer_load_dwordx4 v[148:151], v1, s[8:11], s86 offen offset:0
    s_mov_b64 exec, -1
    v_exp_f32 v163, v163
    v_exp_f32 v164, v164
    v_exp_f32 v165, v165
    v_exp_f32 v166, v166
    v_exp_f32 v167, v167
    v_exp_f32 v168, v168
    v_exp_f32 v169, v169
    v_smfmac_f32_32x32x32_bf16 v[184:199], v[236:239], v[160:167], v252
    v_exp_f32 v170, v170
    v_exp_f32 v171, v171
    v_exp_f32 v172, v172
    v_exp_f32 v173, v173
    v_mfma_f32_32x32x16_bf16 v[152:167], v[216:219], v[240:243], 0
    v_exp_f32 v174, v174
    v_exp_f32 v175, v175
    v_exp_f32 v176, v176
    v_exp_f32 v177, v177
    v_exp_f32 v178, v178
    v_smfmac_f32_32x32x32_bf16 v[200:215], v[232:235], v[168:175], v252
    s_add_u32 s36, s36, 4096
    buffer_load_dwordx4 v[24:27], v1, s[8:11], s36 offen offset:0
    v_exp_f32 v179, v179
    v_exp_f32 v180, v180
    v_exp_f32 v181, v181
    v_exp_f32 v182, v182
    v_exp_f32 v183, v183
    s_waitcnt lgkmcnt(0)
    s_setprio 0
    v_exp_f32 v152, v152
    v_exp_f32 v153, v153
    v_smfmac_f32_32x32x32_bf16 v[200:215], v[236:239], v[176:183], v252
    s_mov_b64 exec, s[28:29]
    ds_read_b128 v[232:235], v253 offset:54272
    ds_read_b128 v[236:239], v253 offset:54528
    s_mov_b64 exec, -1
    v_exp_f32 v154, v154
    v_exp_f32 v155, v155
    v_exp_f32 v156, v156
    v_exp_f32 v157, v157
    v_mfma_f32_32x32x16_bf16 v[168:183], v[216:219], v[244:247], 0
    ds_read_b128 v[216:219], v253 offset:57344
    v_exp_f32 v158, v158
    v_exp_f32 v159, v159
    v_exp_f32 v160, v160
    v_exp_f32 v161, v161
    v_exp_f32 v162, v162
    v_smfmac_f32_32x32x32_bf16 v[184:199], v[224:227], v[152:159], v252
    buffer_load_dwordx4 v[28:31], v1, s[8:11], s36 offen offset:1024
    buffer_load_dwordx4 v1, s[8:11], s32 offen offset:3072 lds
    v_exp_f32 v163, v163
    v_exp_f32 v164, v164
    v_exp_f32 v165, v165
    v_exp_f32 v166, v166
    v_exp_f32 v167, v167
    v_exp_f32 v168, v168
    v_exp_f32 v169, v169
    v_smfmac_f32_32x32x32_bf16 v[184:199], v[228:231], v[160:167], v252
    v_exp_f32 v170, v170
    v_exp_f32 v171, v171
    v_exp_f32 v172, v172
    v_exp_f32 v173, v173
    v_mfma_f32_32x32x16_bf16 v[152:167], v[220:223], v[240:243], 0
    v_exp_f32 v174, v174
    v_exp_f32 v175, v175
    v_exp_f32 v176, v176
    v_exp_f32 v177, v177
    v_exp_f32 v178, v178
    v_smfmac_f32_32x32x32_bf16 v[200:215], v[224:227], v[168:175], v252
    v_exp_f32 v179, v179
    v_exp_f32 v180, v180
    v_exp_f32 v181, v181
    v_exp_f32 v182, v182
    v_exp_f32 v183, v183
    s_waitcnt lgkmcnt(0)
    v_exp_f32 v152, v152
    v_exp_f32 v153, v153
    v_smfmac_f32_32x32x32_bf16 v[200:215], v[228:231], v[176:183], v252
    s_mov_b64 exec, s[28:29]
    ds_read_b128 v[224:227], v253 offset:58368
    ds_read_b128 v[228:231], v253 offset:58624
    s_mov_b64 exec, -1
    v_exp_f32 v154, v154
    v_exp_f32 v155, v155
    v_exp_f32 v156, v156
    v_exp_f32 v157, v157
    v_mfma_f32_32x32x16_bf16 v[168:183], v[220:223], v[244:247], 0
    ds_read_b128 v[220:223], v253 offset:61440
    v_exp_f32 v158, v158
    v_exp_f32 v159, v159
    v_exp_f32 v160, v160
    v_exp_f32 v161, v161
    v_exp_f32 v162, v162
    v_smfmac_f32_32x32x32_bf16 v[184:199], v[232:235], v[152:159], v252
    buffer_load_dwordx4 v[32:35], v1, s[8:11], s36 offen offset:2048
    v_exp_f32 v163, v163
    v_exp_f32 v164, v164
    v_exp_f32 v165, v165
    v_exp_f32 v166, v166
    v_exp_f32 v167, v167
    v_exp_f32 v168, v168
    v_exp_f32 v169, v169
    v_smfmac_f32_32x32x32_bf16 v[184:199], v[236:239], v[160:167], v252
    v_exp_f32 v170, v170
    v_exp_f32 v171, v171
    v_exp_f32 v172, v172
    v_exp_f32 v173, v173
    v_mfma_f32_32x32x16_bf16 v[152:167], v[216:219], v[240:243], 0
    v_exp_f32 v174, v174
    v_exp_f32 v175, v175
    v_exp_f32 v176, v176
    v_exp_f32 v177, v177
    v_exp_f32 v178, v178
    v_smfmac_f32_32x32x32_bf16 v[200:215], v[232:235], v[168:175], v252
    buffer_load_dwordx4 v[36:39], v1, s[8:11], s36 offen offset:3072
    v_exp_f32 v179, v179
    v_exp_f32 v180, v180
    v_exp_f32 v181, v181
    v_exp_f32 v182, v182
    v_exp_f32 v183, v183
    s_waitcnt vmcnt(12) lgkmcnt(0)
    s_barrier
    s_setprio 3
    v_exp_f32 v152, v152
    v_exp_f32 v153, v153
    v_smfmac_f32_32x32x32_bf16 v[200:215], v[236:239], v[176:183], v252
    s_mov_b64 exec, s[28:29]
    ds_read_b128 v[232:235], v253 offset:62464
    ds_read_b128 v[236:239], v253 offset:62720
    s_mov_b64 exec, -1
    v_exp_f32 v154, v154
    v_exp_f32 v155, v155
    v_exp_f32 v156, v156
    v_exp_f32 v157, v157
    v_mfma_f32_32x32x16_bf16 v[168:183], v[216:219], v[244:247], 0
    ds_read_b128 v[216:219], v254 offset:0
    v_exp_f32 v158, v158
    v_exp_f32 v159, v159
    v_exp_f32 v160, v160
    v_exp_f32 v161, v161
    v_exp_f32 v162, v162
    v_smfmac_f32_32x32x32_bf16 v[184:199], v[224:227], v[152:159], v252
    s_add_u32 m0, s40, 32768
    s_add_u32 s32, s34, m0
    buffer_load_dwordx4 v1, s[8:11], s32 offen offset:0 lds
    v_exp_f32 v163, v163
    v_exp_f32 v164, v164
    v_exp_f32 v165, v165
    v_exp_f32 v166, v166
    v_exp_f32 v167, v167
    v_exp_f32 v168, v168
    v_exp_f32 v169, v169
    v_smfmac_f32_32x32x32_bf16 v[184:199], v[228:231], v[160:167], v252
    v_exp_f32 v170, v170
    v_exp_f32 v171, v171
    v_exp_f32 v172, v172
    v_exp_f32 v173, v173
    v_mfma_f32_32x32x16_bf16 v[152:167], v[220:223], v[240:243], 0
    v_exp_f32 v174, v174
    v_exp_f32 v175, v175
    v_exp_f32 v176, v176
    v_exp_f32 v177, v177
    v_exp_f32 v178, v178
    v_smfmac_f32_32x32x32_bf16 v[200:215], v[224:227], v[168:175], v252
    s_add_u32 s36, s36, 4096
    buffer_load_dwordx4 v[40:43], v1, s[8:11], s36 offen offset:0
    v_exp_f32 v179, v179
    v_exp_f32 v180, v180
    v_exp_f32 v181, v181
    v_exp_f32 v182, v182
    v_exp_f32 v183, v183
    s_waitcnt lgkmcnt(0)
    v_exp_f32 v152, v152
    v_exp_f32 v153, v153
    v_smfmac_f32_32x32x32_bf16 v[200:215], v[228:231], v[176:183], v252
    s_mov_b64 exec, s[28:29]
    ds_read_b128 v[224:227], v254 offset:1024
    ds_read_b128 v[228:231], v254 offset:1280
    s_mov_b64 exec, -1
    v_exp_f32 v154, v154
    v_exp_f32 v155, v155
    v_exp_f32 v156, v156
    v_exp_f32 v157, v157
    v_mfma_f32_32x32x16_bf16 v[168:183], v[220:223], v[244:247], 0
    ds_read_b128 v[220:223], v254 offset:4096
    v_exp_f32 v158, v158
    v_exp_f32 v159, v159
    v_exp_f32 v160, v160
    v_exp_f32 v161, v161
    v_exp_f32 v162, v162
    v_smfmac_f32_32x32x32_bf16 v[184:199], v[232:235], v[152:159], v252
    buffer_load_dwordx4 v[44:47], v1, s[8:11], s36 offen offset:1024
    buffer_load_dwordx4 v[48:51], v1, s[8:11], s36 offen offset:2048
    v_exp_f32 v163, v163
    v_exp_f32 v164, v164
    v_exp_f32 v165, v165
    v_exp_f32 v166, v166
    v_exp_f32 v167, v167
    v_exp_f32 v168, v168
    v_exp_f32 v169, v169
    v_smfmac_f32_32x32x32_bf16 v[184:199], v[236:239], v[160:167], v252
    v_exp_f32 v170, v170
    v_exp_f32 v171, v171
    v_exp_f32 v172, v172
    v_exp_f32 v173, v173
    v_mfma_f32_32x32x16_bf16 v[152:167], v[216:219], v[240:243], 0
    v_exp_f32 v174, v174
    v_exp_f32 v175, v175
    v_exp_f32 v176, v176
    v_exp_f32 v177, v177
    v_exp_f32 v178, v178
    v_smfmac_f32_32x32x32_bf16 v[200:215], v[232:235], v[168:175], v252
    s_mov_b64 exec, s[90:91]
    buffer_load_dwordx4 v[148:151], v1, s[8:11], s87 offen offset:0
    s_mov_b64 exec, -1
    buffer_load_dwordx4 v1, s[8:11], s32 offen offset:1024 lds
    v_exp_f32 v179, v179
    v_exp_f32 v180, v180
    v_exp_f32 v181, v181
    v_exp_f32 v182, v182
    v_exp_f32 v183, v183
    s_waitcnt lgkmcnt(0)
    s_setprio 2
    v_exp_f32 v152, v152
    v_exp_f32 v153, v153
    v_smfmac_f32_32x32x32_bf16 v[200:215], v[236:239], v[176:183], v252
    s_mov_b64 exec, s[28:29]
    ds_read_b128 v[232:235], v254 offset:5120
    ds_read_b128 v[236:239], v254 offset:5376
    s_mov_b64 exec, -1
    v_exp_f32 v154, v154
    v_exp_f32 v155, v155
    v_exp_f32 v156, v156
    v_exp_f32 v157, v157
    v_mfma_f32_32x32x16_bf16 v[168:183], v[216:219], v[244:247], 0
    ds_read_b128 v[216:219], v254 offset:8192
    v_exp_f32 v158, v158
    v_exp_f32 v159, v159
    v_exp_f32 v160, v160
    v_exp_f32 v161, v161
    v_exp_f32 v162, v162
    v_smfmac_f32_32x32x32_bf16 v[184:199], v[224:227], v[152:159], v252
    buffer_load_dwordx4 v[52:55], v1, s[8:11], s36 offen offset:3072
    v_exp_f32 v163, v163
    v_exp_f32 v164, v164
    v_exp_f32 v165, v165
    v_exp_f32 v166, v166
    v_exp_f32 v167, v167
    v_exp_f32 v168, v168
    v_exp_f32 v169, v169
    v_smfmac_f32_32x32x32_bf16 v[184:199], v[228:231], v[160:167], v252
    v_exp_f32 v170, v170
    v_exp_f32 v171, v171
    v_exp_f32 v172, v172
    v_exp_f32 v173, v173
    v_mfma_f32_32x32x16_bf16 v[152:167], v[220:223], v[240:243], 0
    v_exp_f32 v174, v174
    v_exp_f32 v175, v175
    v_exp_f32 v176, v176
    v_exp_f32 v177, v177
    v_exp_f32 v178, v178
    v_smfmac_f32_32x32x32_bf16 v[200:215], v[224:227], v[168:175], v252
    s_add_u32 s36, s36, 4096
    buffer_load_dwordx4 v[56:59], v1, s[8:11], s36 offen offset:0
    buffer_load_dwordx4 v[60:63], v1, s[8:11], s36 offen offset:1024
    v_exp_f32 v179, v179
    v_exp_f32 v180, v180
    v_exp_f32 v181, v181
    v_exp_f32 v182, v182
    v_exp_f32 v183, v183
    s_waitcnt lgkmcnt(0)
    v_exp_f32 v152, v152
    v_exp_f32 v153, v153
    v_smfmac_f32_32x32x32_bf16 v[200:215], v[228:231], v[176:183], v252
    s_mov_b64 exec, s[28:29]
    ds_read_b128 v[224:227], v254 offset:9216
    ds_read_b128 v[228:231], v254 offset:9472
    s_mov_b64 exec, -1
    v_exp_f32 v154, v154
    v_exp_f32 v155, v155
    v_exp_f32 v156, v156
    v_exp_f32 v157, v157
    v_mfma_f32_32x32x16_bf16 v[168:183], v[220:223], v[244:247], 0
    ds_read_b128 v[220:223], v254 offset:12288
    v_exp_f32 v158, v158
    v_exp_f32 v159, v159
    v_exp_f32 v160, v160
    v_exp_f32 v161, v161
    v_exp_f32 v162, v162
    v_smfmac_f32_32x32x32_bf16 v[184:199], v[232:235], v[152:159], v252
    buffer_load_dwordx4 v1, s[8:11], s32 offen offset:2048 lds
    v_exp_f32 v163, v163
    v_exp_f32 v164, v164
    v_exp_f32 v165, v165
    v_exp_f32 v166, v166
    v_exp_f32 v167, v167
    v_exp_f32 v168, v168
    v_exp_f32 v169, v169
    v_smfmac_f32_32x32x32_bf16 v[184:199], v[236:239], v[160:167], v252
    v_exp_f32 v170, v170
    v_exp_f32 v171, v171
    v_exp_f32 v172, v172
    v_exp_f32 v173, v173
    v_mfma_f32_32x32x16_bf16 v[152:167], v[216:219], v[240:243], 0
    v_exp_f32 v174, v174
    v_exp_f32 v175, v175
    v_exp_f32 v176, v176
    v_exp_f32 v177, v177
    v_exp_f32 v178, v178
    v_smfmac_f32_32x32x32_bf16 v[200:215], v[232:235], v[168:175], v252
    v_exp_f32 v179, v179
    v_exp_f32 v180, v180
    v_exp_f32 v181, v181
    v_exp_f32 v182, v182
    v_exp_f32 v183, v183
    s_waitcnt lgkmcnt(0)
    v_exp_f32 v152, v152
    v_exp_f32 v153, v153
    v_smfmac_f32_32x32x32_bf16 v[200:215], v[236:239], v[176:183], v252
    s_mov_b64 exec, s[28:29]
    ds_read_b128 v[232:235], v254 offset:13312
    ds_read_b128 v[236:239], v254 offset:13568
    s_mov_b64 exec, -1
    v_exp_f32 v154, v154
    v_exp_f32 v155, v155
    v_exp_f32 v156, v156
    v_exp_f32 v157, v157
    v_mfma_f32_32x32x16_bf16 v[168:183], v[216:219], v[244:247], 0
    ds_read_b128 v[216:219], v254 offset:16384
    v_exp_f32 v158, v158
    v_exp_f32 v159, v159
    v_exp_f32 v160, v160
    v_exp_f32 v161, v161
    v_exp_f32 v162, v162
    v_smfmac_f32_32x32x32_bf16 v[184:199], v[224:227], v[152:159], v252
    buffer_load_dwordx4 v[64:67], v1, s[8:11], s36 offen offset:2048
    buffer_load_dwordx4 v[68:71], v1, s[8:11], s36 offen offset:3072
    v_exp_f32 v163, v163
    v_exp_f32 v164, v164
    v_exp_f32 v165, v165
    v_exp_f32 v166, v166
    v_exp_f32 v167, v167
    v_exp_f32 v168, v168
    v_exp_f32 v169, v169
    v_smfmac_f32_32x32x32_bf16 v[184:199], v[228:231], v[160:167], v252
    v_exp_f32 v170, v170
    v_exp_f32 v171, v171
    v_exp_f32 v172, v172
    v_exp_f32 v173, v173
    v_mfma_f32_32x32x16_bf16 v[152:167], v[220:223], v[240:243], 0
    v_exp_f32 v174, v174
    v_exp_f32 v175, v175
    v_exp_f32 v176, v176
    v_exp_f32 v177, v177
    v_exp_f32 v178, v178
    v_smfmac_f32_32x32x32_bf16 v[200:215], v[224:227], v[168:175], v252
    buffer_load_dwordx4 v1, s[8:11], s32 offen offset:3072 lds
    v_exp_f32 v179, v179
    v_exp_f32 v180, v180
    v_exp_f32 v181, v181
    v_exp_f32 v182, v182
    v_exp_f32 v183, v183
    s_waitcnt lgkmcnt(0)
    s_setprio 1
    v_exp_f32 v152, v152
    v_exp_f32 v153, v153
    v_smfmac_f32_32x32x32_bf16 v[200:215], v[228:231], v[176:183], v252
    s_mov_b64 exec, s[28:29]
    ds_read_b128 v[224:227], v254 offset:17408
    ds_read_b128 v[228:231], v254 offset:17664
    s_mov_b64 exec, -1
    v_exp_f32 v154, v154
    v_exp_f32 v155, v155
    v_exp_f32 v156, v156
    v_exp_f32 v157, v157
    v_mfma_f32_32x32x16_bf16 v[168:183], v[220:223], v[244:247], 0
    ds_read_b128 v[220:223], v254 offset:20480
    v_exp_f32 v158, v158
    v_exp_f32 v159, v159
    v_exp_f32 v160, v160
    v_exp_f32 v161, v161
    v_exp_f32 v162, v162
    v_smfmac_f32_32x32x32_bf16 v[184:199], v[232:235], v[152:159], v252
    buffer_load_dwordx4 v[248:251], v255, s[56:59], s39 offen sc1
    v_exp_f32 v163, v163
    v_exp_f32 v164, v164
    v_exp_f32 v165, v165
    v_exp_f32 v166, v166
    v_exp_f32 v167, v167
    v_exp_f32 v168, v168
    v_exp_f32 v169, v169
    v_smfmac_f32_32x32x32_bf16 v[184:199], v[236:239], v[160:167], v252
    v_exp_f32 v170, v170
    v_exp_f32 v171, v171
    v_exp_f32 v172, v172
    v_exp_f32 v173, v173
    v_mfma_f32_32x32x16_bf16 v[152:167], v[216:219], v[240:243], 0
    v_exp_f32 v174, v174
    v_exp_f32 v175, v175
    v_exp_f32 v176, v176
    v_exp_f32 v177, v177
    v_exp_f32 v178, v178
    v_smfmac_f32_32x32x32_bf16 v[200:215], v[232:235], v[168:175], v252
    buffer_load_dwordx4 v[72:75], v1, s[8:11], s44 offen offset:0
    v_exp_f32 v179, v179
    v_exp_f32 v180, v180
    v_exp_f32 v181, v181
    v_exp_f32 v182, v182
    v_exp_f32 v183, v183
    s_waitcnt lgkmcnt(0)
    v_exp_f32 v152, v152
    v_exp_f32 v153, v153
    v_smfmac_f32_32x32x32_bf16 v[200:215], v[236:239], v[176:183], v252
    s_mov_b64 exec, s[28:29]
    ds_read_b128 v[232:235], v254 offset:21504
    ds_read_b128 v[236:239], v254 offset:21760
    s_mov_b64 exec, -1
    v_exp_f32 v154, v154
    v_exp_f32 v155, v155
    v_exp_f32 v156, v156
    v_exp_f32 v157, v157
    v_mfma_f32_32x32x16_bf16 v[168:183], v[216:219], v[244:247], 0
    ds_read_b128 v[216:219], v254 offset:24576
    v_exp_f32 v158, v158
    v_exp_f32 v159, v159
    v_exp_f32 v160, v160
    v_exp_f32 v161, v161
    v_exp_f32 v162, v162
    v_smfmac_f32_32x32x32_bf16 v[184:199], v[224:227], v[152:159], v252
    s_mov_b64 exec, s[90:91]
    buffer_load_dwordx4 v[148:151], v1, s[8:11], s88 offen offset:0
    s_mov_b64 exec, -1
    buffer_load_dwordx4 v[76:79], v1, s[8:11], s44 offen offset:1024
    s_add_u32 m0, s40, 36864
    s_add_u32 s32, s34, m0
    buffer_load_dwordx4 v1, s[8:11], s32 offen offset:0 lds
    v_exp_f32 v163, v163
    v_exp_f32 v164, v164
    v_exp_f32 v165, v165
    v_exp_f32 v166, v166
    v_exp_f32 v167, v167
    v_exp_f32 v168, v168
    v_exp_f32 v169, v169
    v_smfmac_f32_32x32x32_bf16 v[184:199], v[228:231], v[160:167], v252
    v_exp_f32 v170, v170
    v_exp_f32 v171, v171
    v_exp_f32 v172, v172
    v_exp_f32 v173, v173
    v_mfma_f32_32x32x16_bf16 v[152:167], v[220:223], v[240:243], 0
    v_exp_f32 v174, v174
    v_exp_f32 v175, v175
    v_exp_f32 v176, v176
    v_exp_f32 v177, v177
    v_exp_f32 v178, v178
    v_smfmac_f32_32x32x32_bf16 v[200:215], v[224:227], v[168:175], v252
    v_exp_f32 v179, v179
    v_exp_f32 v180, v180
    v_exp_f32 v181, v181
    v_exp_f32 v182, v182
    v_exp_f32 v183, v183
    s_waitcnt lgkmcnt(0)
    v_exp_f32 v152, v152
    v_exp_f32 v153, v153
    v_smfmac_f32_32x32x32_bf16 v[200:215], v[228:231], v[176:183], v252
    s_mov_b64 exec, s[28:29]
    ds_read_b128 v[224:227], v254 offset:25600
    ds_read_b128 v[228:231], v254 offset:25856
    s_mov_b64 exec, -1
    v_exp_f32 v154, v154
    v_exp_f32 v155, v155
    v_exp_f32 v156, v156
    v_exp_f32 v157, v157
    v_mfma_f32_32x32x16_bf16 v[168:183], v[220:223], v[244:247], 0
    ds_read_b128 v[220:223], v254 offset:28672
    v_exp_f32 v158, v158
    v_exp_f32 v159, v159
    v_exp_f32 v160, v160
    v_exp_f32 v161, v161
    v_exp_f32 v162, v162
    v_smfmac_f32_32x32x32_bf16 v[184:199], v[232:235], v[152:159], v252
    buffer_load_dwordx4 v[80:83], v1, s[8:11], s44 offen offset:2048
    buffer_load_dwordx4 v[84:87], v1, s[8:11], s44 offen offset:3072
    v_exp_f32 v163, v163
    v_exp_f32 v164, v164
    v_exp_f32 v165, v165
    v_exp_f32 v166, v166
    v_exp_f32 v167, v167
    v_exp_f32 v168, v168
    v_exp_f32 v169, v169
    v_smfmac_f32_32x32x32_bf16 v[184:199], v[236:239], v[160:167], v252
    v_exp_f32 v170, v170
    v_exp_f32 v171, v171
    v_exp_f32 v172, v172
    v_exp_f32 v173, v173
    v_mfma_f32_32x32x16_bf16 v[152:167], v[216:219], v[240:243], 0
    v_exp_f32 v174, v174
    v_exp_f32 v175, v175
    v_exp_f32 v176, v176
    v_exp_f32 v177, v177
    v_exp_f32 v178, v178
    v_smfmac_f32_32x32x32_bf16 v[200:215], v[232:235], v[168:175], v252
    buffer_load_dwordx4 v1, s[8:11], s32 offen offset:1024 lds
    v_exp_f32 v179, v179
    v_exp_f32 v180, v180
    v_exp_f32 v181, v181
    v_exp_f32 v182, v182
    v_exp_f32 v183, v183
    s_waitcnt lgkmcnt(0)
    s_setprio 0
    v_exp_f32 v152, v152
    v_exp_f32 v153, v153
    v_smfmac_f32_32x32x32_bf16 v[200:215], v[236:239], v[176:183], v252
    s_mov_b64 exec, s[28:29]
    ds_read_b128 v[232:235], v254 offset:29696
    ds_read_b128 v[236:239], v254 offset:29952
    s_mov_b64 exec, -1
    v_exp_f32 v154, v154
    v_exp_f32 v155, v155
    v_exp_f32 v156, v156
    v_exp_f32 v157, v157
    v_mfma_f32_32x32x16_bf16 v[168:183], v[216:219], v[244:247], 0
    ds_read_b128 v[216:219], v254 offset:32768
    v_exp_f32 v158, v158
    v_exp_f32 v159, v159
    v_exp_f32 v160, v160
    v_exp_f32 v161, v161
    v_exp_f32 v162, v162
    v_smfmac_f32_32x32x32_bf16 v[184:199], v[224:227], v[152:159], v252
    v_exp_f32 v163, v163
    v_exp_f32 v164, v164
    v_exp_f32 v165, v165
    v_exp_f32 v166, v166
    v_exp_f32 v167, v167
    v_exp_f32 v168, v168
    v_exp_f32 v169, v169
    v_smfmac_f32_32x32x32_bf16 v[184:199], v[228:231], v[160:167], v252
    v_exp_f32 v170, v170
    v_exp_f32 v171, v171
    v_exp_f32 v172, v172
    v_exp_f32 v173, v173
    v_mfma_f32_32x32x16_bf16 v[152:167], v[220:223], v[240:243], 0
    v_exp_f32 v174, v174
    v_exp_f32 v175, v175
    v_exp_f32 v176, v176
    v_exp_f32 v177, v177
    v_exp_f32 v178, v178
    v_smfmac_f32_32x32x32_bf16 v[200:215], v[224:227], v[168:175], v252
    s_add_u32 s44, s44, 4096
    buffer_load_dwordx4 v[88:91], v1, s[8:11], s44 offen offset:0
    buffer_load_dwordx4 v[92:95], v1, s[8:11], s44 offen offset:1024
    v_exp_f32 v179, v179
    v_exp_f32 v180, v180
    v_exp_f32 v181, v181
    v_exp_f32 v182, v182
    v_exp_f32 v183, v183
    s_waitcnt lgkmcnt(0)
    v_exp_f32 v152, v152
    v_exp_f32 v153, v153
    v_smfmac_f32_32x32x32_bf16 v[200:215], v[228:231], v[176:183], v252
    s_mov_b64 exec, s[28:29]
    ds_read_b128 v[224:227], v254 offset:33792
    ds_read_b128 v[228:231], v254 offset:34048
    s_mov_b64 exec, -1
    v_exp_f32 v154, v154
    v_exp_f32 v155, v155
    v_exp_f32 v156, v156
    v_exp_f32 v157, v157
    v_mfma_f32_32x32x16_bf16 v[168:183], v[220:223], v[244:247], 0
    ds_read_b128 v[220:223], v254 offset:36864
    v_exp_f32 v158, v158
    v_exp_f32 v159, v159
    v_exp_f32 v160, v160
    v_exp_f32 v161, v161
    v_exp_f32 v162, v162
    v_smfmac_f32_32x32x32_bf16 v[184:199], v[232:235], v[152:159], v252
    buffer_load_dwordx4 v[96:99], v1, s[8:11], s44 offen offset:2048
    v_exp_f32 v163, v163
    v_exp_f32 v164, v164
    v_exp_f32 v165, v165
    v_exp_f32 v166, v166
    v_exp_f32 v167, v167
    v_exp_f32 v168, v168
    v_exp_f32 v169, v169
    v_smfmac_f32_32x32x32_bf16 v[184:199], v[236:239], v[160:167], v252
    v_exp_f32 v170, v170
    v_exp_f32 v171, v171
    v_exp_f32 v172, v172
    v_exp_f32 v173, v173
    v_mfma_f32_32x32x16_bf16 v[152:167], v[216:219], v[240:243], 0
    v_exp_f32 v174, v174
    v_exp_f32 v175, v175
    v_exp_f32 v176, v176
    v_exp_f32 v177, v177
    v_exp_f32 v178, v178
    v_smfmac_f32_32x32x32_bf16 v[200:215], v[232:235], v[168:175], v252
    buffer_load_dwordx4 v1, s[8:11], s32 offen offset:2048 lds
    v_exp_f32 v179, v179
    v_exp_f32 v180, v180
    v_exp_f32 v181, v181
    v_exp_f32 v182, v182
    v_exp_f32 v183, v183
    s_waitcnt lgkmcnt(0)
    v_exp_f32 v152, v152
    v_exp_f32 v153, v153
    v_smfmac_f32_32x32x32_bf16 v[200:215], v[236:239], v[176:183], v252
    s_mov_b64 exec, s[28:29]
    ds_read_b128 v[232:235], v254 offset:37888
    ds_read_b128 v[236:239], v254 offset:38144
    s_mov_b64 exec, -1
    v_exp_f32 v154, v154
    v_exp_f32 v155, v155
    v_exp_f32 v156, v156
    v_exp_f32 v157, v157
    v_mfma_f32_32x32x16_bf16 v[168:183], v[216:219], v[244:247], 0
    ds_read_b128 v[216:219], v254 offset:40960
    v_exp_f32 v158, v158
    v_exp_f32 v159, v159
    v_exp_f32 v160, v160
    v_exp_f32 v161, v161
    v_exp_f32 v162, v162
    v_smfmac_f32_32x32x32_bf16 v[184:199], v[224:227], v[152:159], v252
    buffer_load_dwordx4 v[100:103], v1, s[8:11], s44 offen offset:3072
    v_exp_f32 v163, v163
    v_exp_f32 v164, v164
    v_exp_f32 v165, v165
    v_exp_f32 v166, v166
    v_exp_f32 v167, v167
    v_exp_f32 v168, v168
    v_exp_f32 v169, v169
    v_smfmac_f32_32x32x32_bf16 v[184:199], v[228:231], v[160:167], v252
    v_exp_f32 v170, v170
    v_exp_f32 v171, v171
    v_exp_f32 v172, v172
    v_exp_f32 v173, v173
    v_mfma_f32_32x32x16_bf16 v[152:167], v[220:223], v[240:243], 0
    v_exp_f32 v174, v174
    v_exp_f32 v175, v175
    v_exp_f32 v176, v176
    v_exp_f32 v177, v177
    v_exp_f32 v178, v178
    v_smfmac_f32_32x32x32_bf16 v[200:215], v[224:227], v[168:175], v252
    s_mov_b64 exec, s[90:91]
    buffer_load_dwordx4 v[148:151], v1, s[8:11], s89 offen offset:0
    s_mov_b64 exec, -1
    s_add_u32 s44, s44, 4096
    buffer_load_dwordx4 v[104:107], v1, s[8:11], s44 offen offset:0
    v_exp_f32 v179, v179
    v_exp_f32 v180, v180
    v_exp_f32 v181, v181
    v_exp_f32 v182, v182
    v_exp_f32 v183, v183
    s_waitcnt lgkmcnt(0)
    s_barrier
    s_setprio 3
    v_exp_f32 v152, v152
    v_exp_f32 v153, v153
    v_smfmac_f32_32x32x32_bf16 v[200:215], v[228:231], v[176:183], v252
    s_mov_b64 exec, s[28:29]
    ds_read_b128 v[224:227], v254 offset:41984
    ds_read_b128 v[228:231], v254 offset:42240
    s_mov_b64 exec, -1
    v_exp_f32 v154, v154
    v_exp_f32 v155, v155
    v_exp_f32 v156, v156
    v_exp_f32 v157, v157
    v_mfma_f32_32x32x16_bf16 v[168:183], v[220:223], v[244:247], 0
    ds_read_b128 v[220:223], v254 offset:45056
    v_exp_f32 v158, v158
    v_exp_f32 v159, v159
    v_exp_f32 v160, v160
    v_exp_f32 v161, v161
    v_exp_f32 v162, v162
    v_smfmac_f32_32x32x32_bf16 v[184:199], v[232:235], v[152:159], v252
    s_add_u32 m0, s41, 90112
    s_add_u32 s32, s34, m0
    buffer_load_dwordx4 v1, s[8:11], s32 offen offset:0 lds
    v_exp_f32 v163, v163
    v_exp_f32 v164, v164
    v_exp_f32 v165, v165
    v_exp_f32 v166, v166
    v_exp_f32 v167, v167
    v_exp_f32 v168, v168
    v_exp_f32 v169, v169
    v_smfmac_f32_32x32x32_bf16 v[184:199], v[236:239], v[160:167], v252
    v_exp_f32 v170, v170
    v_exp_f32 v171, v171
    v_exp_f32 v172, v172
    v_exp_f32 v173, v173
    v_mfma_f32_32x32x16_bf16 v[152:167], v[216:219], v[240:243], 0
    v_exp_f32 v174, v174
    v_exp_f32 v175, v175
    v_exp_f32 v176, v176
    v_exp_f32 v177, v177
    v_exp_f32 v178, v178
    v_smfmac_f32_32x32x32_bf16 v[200:215], v[232:235], v[168:175], v252
    buffer_load_dword v3, v2, s[8:11], 0 offen sc1
    v_exp_f32 v179, v179
    v_exp_f32 v180, v180
    v_exp_f32 v181, v181
    v_exp_f32 v182, v182
    v_exp_f32 v183, v183
    s_waitcnt lgkmcnt(0)
    v_exp_f32 v152, v152
    v_exp_f32 v153, v153
    v_smfmac_f32_32x32x32_bf16 v[200:215], v[236:239], v[176:183], v252
    s_mov_b64 exec, s[28:29]
    ds_read_b128 v[232:235], v254 offset:46080
    ds_read_b128 v[236:239], v254 offset:46336
    s_mov_b64 exec, -1
    v_exp_f32 v154, v154
    v_exp_f32 v155, v155
    v_exp_f32 v156, v156
    v_exp_f32 v157, v157
    v_mfma_f32_32x32x16_bf16 v[168:183], v[216:219], v[244:247], 0
    ds_read_b128 v[216:219], v254 offset:49152
    v_exp_f32 v158, v158
    v_exp_f32 v159, v159
    v_exp_f32 v160, v160
    v_exp_f32 v161, v161
    v_exp_f32 v162, v162
    v_smfmac_f32_32x32x32_bf16 v[184:199], v[224:227], v[152:159], v252
    buffer_load_dwordx4 v[108:111], v1, s[8:11], s44 offen offset:1024
    buffer_load_dwordx4 v[112:115], v1, s[8:11], s44 offen offset:2048
    v_exp_f32 v163, v163
    v_exp_f32 v164, v164
    v_exp_f32 v165, v165
    v_exp_f32 v166, v166
    v_exp_f32 v167, v167
    v_exp_f32 v168, v168
    v_exp_f32 v169, v169
    v_smfmac_f32_32x32x32_bf16 v[184:199], v[228:231], v[160:167], v252
    v_exp_f32 v170, v170
    v_exp_f32 v171, v171
    v_exp_f32 v172, v172
    v_exp_f32 v173, v173
    v_mfma_f32_32x32x16_bf16 v[152:167], v[220:223], v[240:243], 0
    v_exp_f32 v174, v174
    v_exp_f32 v175, v175
    v_exp_f32 v176, v176
    v_exp_f32 v177, v177
    v_exp_f32 v178, v178
    v_smfmac_f32_32x32x32_bf16 v[200:215], v[224:227], v[168:175], v252
    buffer_load_dwordx4 v[116:119], v1, s[8:11], s44 offen offset:3072
    v_exp_f32 v179, v179
    v_exp_f32 v180, v180
    v_exp_f32 v181, v181
    v_exp_f32 v182, v182
    v_exp_f32 v183, v183
    s_waitcnt lgkmcnt(0)
    v_exp_f32 v152, v152
    v_exp_f32 v153, v153
    v_smfmac_f32_32x32x32_bf16 v[200:215], v[228:231], v[176:183], v252
    s_mov_b64 exec, s[28:29]
    ds_read_b128 v[224:227], v254 offset:50176
    ds_read_b128 v[228:231], v254 offset:50432
    s_mov_b64 exec, -1
    v_exp_f32 v154, v154
    v_exp_f32 v155, v155
    v_exp_f32 v156, v156
    v_exp_f32 v157, v157
    v_mfma_f32_32x32x16_bf16 v[168:183], v[220:223], v[244:247], 0
    ds_read_b128 v[220:223], v254 offset:53248
    v_exp_f32 v158, v158
    v_exp_f32 v159, v159
    v_exp_f32 v160, v160
    v_exp_f32 v161, v161
    v_exp_f32 v162, v162
    v_smfmac_f32_32x32x32_bf16 v[184:199], v[232:235], v[152:159], v252
    buffer_load_dwordx4 v1, s[8:11], s32 offen offset:1024 lds
    v_exp_f32 v163, v163
    v_exp_f32 v164, v164
    v_exp_f32 v165, v165
    v_exp_f32 v166, v166
    v_exp_f32 v167, v167
    v_exp_f32 v168, v168
    v_exp_f32 v169, v169
    v_smfmac_f32_32x32x32_bf16 v[184:199], v[236:239], v[160:167], v252
    v_exp_f32 v170, v170
    v_exp_f32 v171, v171
    v_exp_f32 v172, v172
    v_exp_f32 v173, v173
    v_mfma_f32_32x32x16_bf16 v[152:167], v[216:219], v[240:243], 0
    v_exp_f32 v174, v174
    v_exp_f32 v175, v175
    v_exp_f32 v176, v176
    v_exp_f32 v177, v177
    v_exp_f32 v178, v178
    v_smfmac_f32_32x32x32_bf16 v[200:215], v[232:235], v[168:175], v252
    s_add_u32 s44, s44, 4096
    buffer_load_dwordx4 v[120:123], v1, s[8:11], s44 offen offset:0
    v_exp_f32 v179, v179
    v_exp_f32 v180, v180
    v_exp_f32 v181, v181
    v_exp_f32 v182, v182
    v_exp_f32 v183, v183
    s_waitcnt lgkmcnt(0)
    s_setprio 2
    v_exp_f32 v152, v152
    v_exp_f32 v153, v153
    v_smfmac_f32_32x32x32_bf16 v[200:215], v[236:239], v[176:183], v252
    s_mov_b64 exec, s[28:29]
    ds_read_b128 v[232:235], v254 offset:54272
    ds_read_b128 v[236:239], v254 offset:54528
    s_mov_b64 exec, -1
    v_exp_f32 v154, v154
    v_exp_f32 v155, v155
    v_exp_f32 v156, v156
    v_exp_f32 v157, v157
    v_mfma_f32_32x32x16_bf16 v[168:183], v[216:219], v[244:247], 0
    ds_read_b128 v[216:219], v254 offset:57344
    v_exp_f32 v158, v158
    v_exp_f32 v159, v159
    v_exp_f32 v160, v160
    v_exp_f32 v161, v161
    v_exp_f32 v162, v162
    v_smfmac_f32_32x32x32_bf16 v[184:199], v[224:227], v[152:159], v252
    buffer_load_dwordx4 v[124:127], v1, s[8:11], s44 offen offset:1024
    buffer_load_dwordx4 v[128:131], v1, s[8:11], s44 offen offset:2048
    v_exp_f32 v163, v163
    v_exp_f32 v164, v164
    v_exp_f32 v165, v165
    v_exp_f32 v166, v166
    v_exp_f32 v167, v167
    v_exp_f32 v168, v168
    v_exp_f32 v169, v169
    v_smfmac_f32_32x32x32_bf16 v[184:199], v[228:231], v[160:167], v252
    v_exp_f32 v170, v170
    v_exp_f32 v171, v171
    v_exp_f32 v172, v172
    v_exp_f32 v173, v173
    v_mfma_f32_32x32x16_bf16 v[152:167], v[220:223], v[240:243], 0
    v_exp_f32 v174, v174
    v_exp_f32 v175, v175
    v_exp_f32 v176, v176
    v_exp_f32 v177, v177
    v_exp_f32 v178, v178
    v_smfmac_f32_32x32x32_bf16 v[200:215], v[224:227], v[168:175], v252
    buffer_load_dwordx4 v[132:135], v1, s[8:11], s44 offen offset:3072
    v_exp_f32 v179, v179
    v_exp_f32 v180, v180
    v_exp_f32 v181, v181
    v_exp_f32 v182, v182
    v_exp_f32 v183, v183
    s_waitcnt lgkmcnt(0)
    v_exp_f32 v152, v152
    v_exp_f32 v153, v153
    v_smfmac_f32_32x32x32_bf16 v[200:215], v[228:231], v[176:183], v252
    s_mov_b64 exec, s[28:29]
    ds_read_b128 v[224:227], v254 offset:58368
    ds_read_b128 v[228:231], v254 offset:58624
    s_mov_b64 exec, -1
    v_exp_f32 v154, v154
    v_exp_f32 v155, v155
    v_exp_f32 v156, v156
    v_exp_f32 v157, v157
    v_mfma_f32_32x32x16_bf16 v[168:183], v[220:223], v[244:247], 0
    ds_read_b128 v[220:223], v254 offset:61440
    v_exp_f32 v158, v158
    v_exp_f32 v159, v159
    v_exp_f32 v160, v160
    v_exp_f32 v161, v161
    v_exp_f32 v162, v162
    v_smfmac_f32_32x32x32_bf16 v[184:199], v[232:235], v[152:159], v252
    buffer_load_dwordx4 v1, s[8:11], s32 offen offset:2048 lds
    s_xor_b32 s87, s3, 1
    s_mul_i32 s84, s87, 2560
    s_add_u32 s84, s84, 109568
    s_lshl_b32 s86, s87, 12
    v_exp_f32 v163, v163
    v_exp_f32 v164, v164
    v_exp_f32 v165, v165
    v_exp_f32 v166, v166
    v_exp_f32 v167, v167
    v_exp_f32 v168, v168
    v_exp_f32 v169, v169
    v_smfmac_f32_32x32x32_bf16 v[184:199], v[236:239], v[160:167], v252
    v_exp_f32 v170, v170
    v_exp_f32 v171, v171
    v_exp_f32 v172, v172
    v_exp_f32 v173, v173
    v_mfma_f32_32x32x16_bf16 v[152:167], v[216:219], v[240:243], 0
    v_exp_f32 v174, v174
    v_exp_f32 v175, v175
    v_exp_f32 v176, v176
    v_exp_f32 v177, v177
    v_exp_f32 v178, v178
    v_smfmac_f32_32x32x32_bf16 v[200:215], v[232:235], v[168:175], v252
    s_add_u32 s44, s44, 4096
    buffer_load_dwordx4 v[136:139], v1, s[8:11], s44 offen offset:0
    s_add_u32 s86, s86, 131072
    s_cmp_lt_u32 s87, 2
    s_cselect_b32 s84, s86, s84
    s_mul_i32 s85, s3, 2560
    v_exp_f32 v179, v179
    v_exp_f32 v180, v180
    v_exp_f32 v181, v181
    v_exp_f32 v182, v182
    v_exp_f32 v183, v183
    s_waitcnt lgkmcnt(0)
    s_setprio 1
    v_exp_f32 v152, v152
    v_exp_f32 v153, v153
    v_smfmac_f32_32x32x32_bf16 v[200:215], v[236:239], v[176:183], v252
    s_mov_b64 exec, s[28:29]
    ds_read_b128 v[232:235], v254 offset:62464
    ds_read_b128 v[236:239], v254 offset:62720
    s_mov_b64 exec, -1
    v_exp_f32 v154, v154
    v_exp_f32 v155, v155
    v_exp_f32 v156, v156
    v_exp_f32 v157, v157
    v_mfma_f32_32x32x16_bf16 v[168:183], v[216:219], v[244:247], 0
    s_nop 0
    v_exp_f32 v158, v158
    v_exp_f32 v159, v159
    v_exp_f32 v160, v160
    v_exp_f32 v161, v161
    v_exp_f32 v162, v162
    v_smfmac_f32_32x32x32_bf16 v[184:199], v[224:227], v[152:159], v252
    buffer_load_dwordx4 v[140:143], v1, s[8:11], s44 offen offset:1024
    buffer_load_dwordx4 v[144:147], v1, s[8:11], s44 offen offset:2048
    s_add_u32 s85, s85, 109568
    s_lshl_b32 s86, s3, 12
    s_add_u32 s86, s86, 131072
    s_cmp_lt_u32 s3, 2
    s_cselect_b32 s85, s86, s85
    v_exp_f32 v163, v163
    v_exp_f32 v164, v164
    v_exp_f32 v165, v165
    v_exp_f32 v166, v166
    v_exp_f32 v167, v167
    v_exp_f32 v168, v168
    v_exp_f32 v169, v169
    v_smfmac_f32_32x32x32_bf16 v[184:199], v[228:231], v[160:167], v252
    v_exp_f32 v170, v170
    v_exp_f32 v171, v171
    v_exp_f32 v172, v172
    v_exp_f32 v173, v173
    v_mfma_f32_32x32x16_bf16 v[152:167], v[220:223], v[240:243], 0
    v_exp_f32 v174, v174
    v_exp_f32 v175, v175
    v_exp_f32 v176, v176
    v_exp_f32 v177, v177
    v_exp_f32 v178, v178
    v_smfmac_f32_32x32x32_bf16 v[200:215], v[224:227], v[168:175], v252
    buffer_load_dwordx4 v[148:151], v1, s[8:11], s44 offen offset:3072
    v_add_u32 v4, s84, v1
    v_add_u32 v5, s85, v1
    v_lshl_add_u32 v6, v0, 2, s84
    v_lshl_add_u32 v7, v0, 2, s85
    v_exp_f32 v179, v179
    v_exp_f32 v180, v180
    v_exp_f32 v181, v181
    v_exp_f32 v182, v182
    v_exp_f32 v183, v183
    s_waitcnt lgkmcnt(0)
    s_setprio 0
    v_exp_f32 v152, v152
    v_exp_f32 v153, v153
    v_smfmac_f32_32x32x32_bf16 v[200:215], v[228:231], v[176:183], v252
    v_exp_f32 v154, v154
    v_exp_f32 v155, v155
    v_exp_f32 v156, v156
    v_exp_f32 v157, v157
    v_mfma_f32_32x32x16_bf16 v[168:183], v[220:223], v[244:247], 0
    s_nop 0
    v_exp_f32 v158, v158
    v_exp_f32 v159, v159
    v_exp_f32 v160, v160
    v_exp_f32 v161, v161
    v_exp_f32 v162, v162
    v_smfmac_f32_32x32x32_bf16 v[184:199], v[232:235], v[152:159], v252
    s_lshl_b32 s88, s45, 14
    s_add_u32 s88, s88, s38
    s_add_u32 s88, s88, 10485760
    v_exp_f32 v163, v163
    v_exp_f32 v164, v164
    v_exp_f32 v165, v165
    v_exp_f32 v166, v166
    v_exp_f32 v167, v167
    v_exp_f32 v168, v168
    v_exp_f32 v169, v169
    v_smfmac_f32_32x32x32_bf16 v[184:199], v[236:239], v[160:167], v252
    v_exp_f32 v170, v170
    v_exp_f32 v171, v171
    v_exp_f32 v172, v172
    v_exp_f32 v173, v173
    v_exp_f32 v174, v174
    v_exp_f32 v175, v175
    v_exp_f32 v176, v176
    v_exp_f32 v177, v177
    v_exp_f32 v178, v178
    v_smfmac_f32_32x32x32_bf16 v[200:215], v[232:235], v[168:175], v252
    v_exp_f32 v179, v179
    v_exp_f32 v180, v180
    v_exp_f32 v181, v181
    v_exp_f32 v182, v182
    v_exp_f32 v183, v183
    s_nop 1
    v_smfmac_f32_32x32x32_bf16 v[200:215], v[236:239], v[176:183], v252
    s_setprio 0
    s_nop 10
    v_permlane16_swap_b32 v184, v200
    v_permlane16_swap_b32 v185, v201
    v_permlane16_swap_b32 v186, v202
    v_permlane16_swap_b32 v187, v203
    v_permlane16_swap_b32 v188, v204
    v_permlane16_swap_b32 v189, v205
    v_permlane16_swap_b32 v190, v206
    v_permlane16_swap_b32 v191, v207
    v_permlane16_swap_b32 v192, v208
    s_cmp_eq_u32 s45, 0
    s_cbranch_scc1 EX1_63
    v_swap_b32 v184, v200
    v_swap_b32 v185, v201
    v_swap_b32 v186, v202
    v_swap_b32 v187, v203
    v_swap_b32 v188, v204
    v_swap_b32 v189, v205
    v_swap_b32 v190, v206
    v_swap_b32 v191, v207
    v_swap_b32 v192, v208
EX1_63:
    ds_write_b128 v4, v[200:203]
    ds_write_b128 v4, v[204:207] offset:1024
    ds_write_b32 v6, v208 offset:2048
    s_mov_b32 s30, s88
    s_mov_b32 s32, 0x1f800000
    s_mov_b32 s33, 0x5f800000
    s_waitcnt lgkmcnt(0)
    s_barrier
    ds_read_b32 v208, v7 offset:2048
    ds_read_b128 v[200:203], v5
    ds_read_b128 v[204:207], v5 offset:1024
    s_waitcnt vmcnt(0)
    v_cmp_ne_u32 vcc, s50, v3
    s_nop 0
    s_cmp_eq_u64 vcc, 0
    s_cselect_b32 s18, 1, 0
    s_mov_b32 s93, s18
    s_waitcnt lgkmcnt(2)
    v_add_f32 v192, v192, v208
    s_waitcnt lgkmcnt(0)
    v_pk_add_f32 v[184:185], v[184:185], v[200:201]
    v_pk_add_f32 v[186:187], v[186:187], v[202:203]
    v_pk_add_f32 v[188:189], v[188:189], v[204:205]
    v_pk_add_f32 v[190:191], v[190:191], v[206:207]
    v_cmp_le_f32 s[40:41], s32, v192
    v_cmp_ge_f32 s[42:43], s33, v192
    v_add_f32 v4, |v184|, |v185|
    v_add_f32 v5, |v186|, |v187|
    v_add_f32 v6, |v188|, |v189|
    v_add_f32 v7, |v190|, |v191|
    v_add_f32 v4, v4, v5
    v_add_f32 v6, v6, v7
    v_add_f32 v4, v4, v6
    v_cmp_gt_f32 vcc, 0x7f800000, v4
    s_and_b64 s[40:41], s[40:41], s[42:43]
    s_and_b64 s[40:41], s[40:41], vcc
    s_cmp_eq_u64 s[40:41], -1
    s_cbranch_scc0 M_SLOW
M_SLOW_BACK:
    v_rcp_f32 v4, v192
    s_nop 0
    v_mul_f32 v184, v184, v4
    v_mul_f32 v185, v185, v4
    v_mul_f32 v186, v186, v4
    v_mul_f32 v187, v187, v4
    v_mul_f32 v188, v188, v4
    v_mul_f32 v189, v189, v4
    v_mul_f32 v190, v190, v4
    v_mul_f32 v191, v191, v4
    v_cvt_pk_bf16_f32 v252, v184, v185
    v_cvt_pk_bf16_f32 v253, v186, v187
    v_cvt_pk_bf16_f32 v254, v188, v189
    v_cvt_pk_bf16_f32 v255, v190, v191
    s_cmp_eq_u32 s18, 0
    s_cbranch_scc1 GST_65
    buffer_store_dwordx4 v[252:255], v1, s[8:11], s30 offen
GSTB_66:
    s_mov_b32 s43, s30
    s_add_u32 s30, s26, 1
    v_mov_b32 v4, s30
    v_mov_b32 v5, s25
    s_lshl_b32 s30, s19, 2
    s_and_b32 s31, s3, 3
    s_add_u32 s30, s30, s31
    s_lshl_b32 s30, s30, 3
    s_lshr_b32 s31, s3, 2
    s_add_u32 s30, s30, s31
    s_lshl_b32 s30, s30, 2
    s_add_u32 s30, s30, 7405568
    v_and_b32 v2, 3, v0
    v_lshl_add_u32 v2, v2, 3, s30
    s_add_u32 s47, s26, 1
    s_lshl_b32 s33, s3, 12
    s_lshl_b32 s32, s19, 15
    s_add_u32 s32, s32, s33
    s_add_u32 s32, s32, 10485760
    s_add_u32 m0, s33, 131072
    s_waitcnt vmcnt(0)
    s_mov_b64 exec, 1
    s_cmp_eq_u32 s93, 0
    s_cbranch_scc1 GST_67
    buffer_store_dword v4, v5, s[8:11], 0 offen
GSTB_68:
    s_mov_b64 exec, -1
    s_mov_b32 s46, 262144
POLL_69:
    buffer_load_dword v3, v2, s[8:11], 0 offen sc1
    s_waitcnt vmcnt(0)
    v_cmp_gt_u32 vcc, s47, v3
    s_cbranch_vccz POLLD_70
    s_sub_u32 s46, s46, 1
    s_cbranch_scc0 POLL_69
POLLD_70:
    buffer_load_dwordx4 v1, s[8:11], s32 offen offset:0 sc1 lds
    buffer_load_dwordx4 v1, s[8:11], s32 offen offset:1024 sc1 lds
    buffer_load_dwordx4 v1, s[8:11], s32 offen offset:2048 sc1 lds
    buffer_load_dwordx4 v1, s[8:11], s32 offen offset:3072 sc1 lds
    v_add_u32 v2, 131072, v1
    v_lshlrev_b32 v160, 16, v248
    v_and_b32 v161, 0xffff0000, v248
    v_lshlrev_b32 v162, 16, v249
    v_and_b32 v163, 0xffff0000, v249
    v_lshlrev_b32 v164, 16, v250
    v_and_b32 v165, 0xffff0000, v250
    v_lshlrev_b32 v166, 16, v251
    v_and_b32 v167, 0xffff0000, v251
    v_and_b32 v3, 31, v0
    v_lshrrev_b32 v4, 5, v0
    v_lshlrev_b32 v4, 2, v4
    v_lshl_add_u32 v3, v3, 3, v4
    s_lshl_b32 s40, s20, 3
    s_add_u32 s40, s40, s3
    s_lshl_b32 s40, s40, 14
    s_lshl_b32 s41, s19, 8
    s_add_u32 s40, s40, s41
    s_add_u32 s40, s40, 7864320
    s_add_u32 s39, s37, 12582912
    v_bfe_u32 v5, v0, 4, 1
    v_lshlrev_b32 v5, 14, v5
    v_lshl_add_u32 v5, v4, 6, v5
    v_and_b32 v6, 15, v0
    v_lshl_add_u32 v5, v6, 4, v5
    s_waitcnt vmcnt(2)
    s_barrier
    ds_read_b128 v[184:187], v2 offset:0
    ds_read_b128 v[188:191], v2 offset:16384
    ds_read_b128 v[192:195], v2 offset:1024
    ds_read_b128 v[196:199], v2 offset:17408
    ds_read_b128 v[200:203], v2 offset:4096
    ds_read_b128 v[204:207], v2 offset:20480
    ds_read_b128 v[208:211], v2 offset:5120
    ds_read_b128 v[212:215], v2 offset:21504
    ds_read_b128 v[216:219], v2 offset:8192
    ds_read_b128 v[220:223], v2 offset:24576
    ds_read_b128 v[224:227], v2 offset:9216
    ds_read_b128 v[228:231], v2 offset:25600
    s_waitcnt lgkmcnt(10)
    v_mfma_f32_16x16x32_bf16 v[152:155], v[8:11], v[184:187], 0
    v_mfma_f32_16x16x32_bf16 v[156:159], v[8:11], v[188:191], 0
    ds_read_b128 v[232:235], v2 offset:12288
    ds_read_b128 v[236:239], v2 offset:28672
    s_waitcnt lgkmcnt(10)
    v_mfma_f32_16x16x32_bf16 v[152:155], v[12:15], v[192:195], v[152:155]
    v_mfma_f32_16x16x32_bf16 v[156:159], v[12:15], v[196:199], v[156:159]
    ds_read_b128 v[240:243], v2 offset:13312
    ds_read_b128 v[244:247], v2 offset:29696
    s_waitcnt lgkmcnt(10)
    v_mfma_f32_16x16x32_bf16 v[152:155], v[24:27], v[200:203], v[152:155]
    v_mfma_f32_16x16x32_bf16 v[156:159], v[24:27], v[204:207], v[156:159]
    s_waitcnt lgkmcnt(8)
    v_mfma_f32_16x16x32_bf16 v[152:155], v[28:31], v[208:211], v[152:155]
    v_mfma_f32_16x16x32_bf16 v[156:159], v[28:31], v[212:215], v[156:159]
    s_waitcnt lgkmcnt(6)
    v_mfma_f32_16x16x32_bf16 v[152:155], v[40:43], v[216:219], v[152:155]
    v_mfma_f32_16x16x32_bf16 v[156:159], v[40:43], v[220:223], v[156:159]
    s_waitcnt lgkmcnt(4)
    v_mfma_f32_16x16x32_bf16 v[152:155], v[44:47], v[224:227], v[152:155]
    v_mfma_f32_16x16x32_bf16 v[156:159], v[44:47], v[228:231], v[156:159]
    s_waitcnt vmcnt(0)
    s_barrier
    ds_read_b128 v[184:187], v2 offset:2048
    ds_read_b128 v[188:191], v2 offset:18432
    ds_read_b128 v[192:195], v2 offset:3072
    ds_read_b128 v[196:199], v2 offset:19456
    ds_read_b128 v[200:203], v2 offset:6144
    ds_read_b128 v[204:207], v2 offset:22528
    ds_read_b128 v[208:211], v2 offset:7168
    ds_read_b128 v[212:215], v2 offset:23552
    s_waitcnt lgkmcnt(10)
    v_mfma_f32_16x16x32_bf16 v[152:155], v[56:59], v[232:235], v[152:155]
    v_mfma_f32_16x16x32_bf16 v[156:159], v[56:59], v[236:239], v[156:159]
    ds_read_b128 v[216:219], v2 offset:10240
    ds_read_b128 v[220:223], v2 offset:26624
    s_waitcnt lgkmcnt(10)
    v_mfma_f32_16x16x32_bf16 v[152:155], v[60:63], v[240:243], v[152:155]
    v_mfma_f32_16x16x32_bf16 v[156:159], v[60:63], v[244:247], v[156:159]
    ds_read_b128 v[224:227], v2 offset:11264
    ds_read_b128 v[228:231], v2 offset:27648
    s_waitcnt lgkmcnt(10)
    v_mfma_f32_16x16x32_bf16 v[152:155], v[16:19], v[184:187], v[152:155]
    v_mfma_f32_16x16x32_bf16 v[156:159], v[16:19], v[188:191], v[156:159]
    ds_read_b128 v[232:235], v2 offset:14336
    ds_read_b128 v[236:239], v2 offset:30720
    s_waitcnt lgkmcnt(10)
    v_mfma_f32_16x16x32_bf16 v[152:155], v[20:23], v[192:195], v[152:155]
    v_mfma_f32_16x16x32_bf16 v[156:159], v[20:23], v[196:199], v[156:159]
    ds_read_b128 v[240:243], v2 offset:15360
    ds_read_b128 v[244:247], v2 offset:31744
    s_waitcnt lgkmcnt(10)
    v_mfma_f32_16x16x32_bf16 v[152:155], v[32:35], v[200:203], v[152:155]
    v_mfma_f32_16x16x32_bf16 v[156:159], v[32:35], v[204:207], v[156:159]
    s_waitcnt lgkmcnt(8)
    v_mfma_f32_16x16x32_bf16 v[152:155], v[36:39], v[208:211], v[152:155]
    v_mfma_f32_16x16x32_bf16 v[156:159], v[36:39], v[212:215], v[156:159]
    s_waitcnt lgkmcnt(6)
    v_mfma_f32_16x16x32_bf16 v[152:155], v[48:51], v[216:219], v[152:155]
    v_mfma_f32_16x16x32_bf16 v[156:159], v[48:51], v[220:223], v[156:159]
    s_waitcnt lgkmcnt(4)
    v_mfma_f32_16x16x32_bf16 v[152:155], v[52:55], v[224:227], v[152:155]
    v_mfma_f32_16x16x32_bf16 v[156:159], v[52:55], v[228:231], v[156:159]
    s_waitcnt lgkmcnt(2)
    v_mfma_f32_16x16x32_bf16 v[152:155], v[64:67], v[232:235], v[152:155]
    v_mfma_f32_16x16x32_bf16 v[156:159], v[64:67], v[236:239], v[156:159]
    s_waitcnt lgkmcnt(0)
    v_mfma_f32_16x16x32_bf16 v[152:155], v[68:71], v[240:243], v[152:155]
    v_mfma_f32_16x16x32_bf16 v[156:159], v[68:71], v[244:247], v[156:159]
    s_nop 7
    v_permlane16_swap_b32 v152, v156
    v_permlane16_swap_b32 v153, v157
    v_permlane16_swap_b32 v154, v158
    v_permlane16_swap_b32 v155, v159
    v_pk_add_f32 v[152:153], v[152:153], v[160:161]
    v_pk_add_f32 v[154:155], v[154:155], v[162:163]
    v_pk_add_f32 v[156:157], v[156:157], v[164:165]
    v_pk_add_f32 v[158:159], v[158:159], v[166:167]
    v_cvt_pk_bf16_f32 v168, v152, v153
    v_cvt_pk_bf16_f32 v169, v154, v155
    v_cvt_pk_bf16_f32 v170, v156, v157
    v_cvt_pk_bf16_f32 v171, v158, v159
    s_cmp_eq_u32 s18, 0
    s_cbranch_scc1 GST_71
    buffer_store_dwordx4 v[168:171], v5, s[8:11], s39 offen
GSTB_72:
    v_dot2_f32_bf16 v172, v168, s27, 0
    v_dot2_f32_bf16 v173, v168, v168, 0
    v_dot2_f32_bf16 v172, v169, s27, v172
    v_dot2_f32_bf16 v173, v169, v169, v173
    v_dot2_f32_bf16 v172, v170, s27, v172
    v_dot2_f32_bf16 v173, v170, v170, v173
    v_dot2_f32_bf16 v172, v171, s27, v172
    v_dot2_f32_bf16 v173, v171, v171, v173
    s_nop 2
    v_permlane32_swap_b32 v172, v173
    v_add_f32 v172, v172, v173
    s_cmp_eq_u32 s18, 0
    s_cbranch_scc1 GST_73
    buffer_store_dword v172, v3, s[8:11], s40 offen
GSTB_74:
    s_add_u32 s30, s26, 2
    v_mov_b32 v176, s30
    v_mov_b32 v177, s25
    v_bfe_u32 v4, v0, 1, 1
    v_bfe_u32 v5, v0, 2, 4
    v_lshlrev_b32 v5, 1, v5
    v_and_b32 v6, 1, v0
    v_add_u32 v5, v5, v6
    v_lshl_add_u32 v5, v4, 3, v5
    v_and_b32 v5, 31, v5
    v_lshl_add_u32 v5, v4, 5, v5
    v_lshlrev_b32 v4, 4, v5
    v_add_u32 v5, 65536, v4
    ds_read_b128 v[56:59], v4 offset:0
    ds_read_b128 v[60:63], v4 offset:1024
    ds_read_b128 v[64:67], v4 offset:2048
    ds_read_b128 v[68:71], v4 offset:3072
    ds_read_b128 v[240:243], v4 offset:4096
    ds_read_b128 v[244:247], v4 offset:5120
    ds_read_b128 v[248:251], v4 offset:6144
    s_lshl_b32 s30, s24, 3
    s_add_u32 s30, s30, s3
    s_lshl_b32 s31, s30, 7
    s_add_u32 s31, s31, 7405568
    v_and_b32 v2, 31, v0
    v_lshl_add_u32 v2, v2, 2, s31
    s_add_u32 s47, s26, 2
    s_lshl_b32 s32, s30, 15
    s_add_u32 s32, s32, 12582912
    s_add_u32 s33, s32, 16384
    s_waitcnt vmcnt(0)
    s_mov_b64 exec, 1
    s_cmp_eq_u32 s93, 0
    s_cbranch_scc1 GST_75
    buffer_store_dword v176, v177, s[8:11], 0 offen
GSTB_76:
    s_mov_b64 exec, -1
    s_mov_b32 s46, 262144
POLL_77:
    buffer_load_dword v3, v2, s[8:11], 0 offen sc1
    s_waitcnt vmcnt(0)
    v_cmp_gt_u32 vcc, s47, v3
    s_cbranch_vccz POLLD_78
    s_sub_u32 s46, s46, 1
    s_cbranch_scc0 POLL_77
POLLD_78:
    buffer_load_dwordx4 v[8:11], v1, s[8:11], s32 offen offset:0 sc1
    buffer_load_dwordx4 v[12:15], v1, s[8:11], s33 offen offset:0 sc1
    buffer_load_dwordx4 v[16:19], v1, s[8:11], s32 offen offset:1024 sc1
    buffer_load_dwordx4 v[20:23], v1, s[8:11], s33 offen offset:1024 sc1
    buffer_load_dwordx4 v[24:27], v1, s[8:11], s32 offen offset:2048 sc1
    buffer_load_dwordx4 v[28:31], v1, s[8:11], s33 offen offset:2048 sc1
    buffer_load_dwordx4 v[32:35], v1, s[8:11], s32 offen offset:3072 sc1
    buffer_load_dwordx4 v[36:39], v1, s[8:11], s33 offen offset:3072 sc1
    s_lshl_b32 s38, s30, 5
    s_add_u32 s38, s38, s23
    s_mul_i32 s38, s38, 3584
    s_add_u32 s38, s38, 14680064
    v_lshlrev_b32 v6, 3, v0
    s_setprio 3
    s_waitcnt vmcnt(6) lgkmcnt(3)
    v_mfma_f32_16x16x32_bf16 v[184:187], v[56:59], v[8:11], 0
    v_mfma_f32_16x16x32_bf16 v[188:191], v[56:59], v[12:15], 0
    ds_read_b128 v[56:59], v4 offset:7168
    v_mfma_f32_16x16x32_bf16 v[192:195], v[60:63], v[8:11], 0
    v_mfma_f32_16x16x32_bf16 v[196:199], v[60:63], v[12:15], 0
    ds_read_b128 v[60:63], v4 offset:8192
    s_add_u32 s32, s32, 4096
    s_add_u32 s33, s33, 4096
    buffer_load_dwordx4 v[40:43], v1, s[8:11], s32 offen offset:0 sc1
    buffer_load_dwordx4 v[44:47], v1, s[8:11], s33 offen offset:0 sc1
    v_mfma_f32_16x16x32_bf16 v[200:203], v[64:67], v[8:11], 0
    v_mfma_f32_16x16x32_bf16 v[204:207], v[64:67], v[12:15], 0
    ds_read_b128 v[64:67], v4 offset:9216
    v_mfma_f32_16x16x32_bf16 v[208:211], v[68:71], v[8:11], 0
    v_mfma_f32_16x16x32_bf16 v[212:215], v[68:71], v[12:15], 0
    ds_read_b128 v[68:71], v4 offset:10240
    s_waitcnt lgkmcnt(3)
    v_mfma_f32_16x16x32_bf16 v[216:219], v[240:243], v[8:11], 0
    v_mfma_f32_16x16x32_bf16 v[220:223], v[240:243], v[12:15], 0
    ds_read_b128 v[240:243], v4 offset:11264
    v_mfma_f32_16x16x32_bf16 v[224:227], v[244:247], v[8:11], 0
    v_mfma_f32_16x16x32_bf16 v[228:231], v[244:247], v[12:15], 0
    ds_read_b128 v[244:247], v4 offset:12288
    v_mfma_f32_16x16x32_bf16 v[232:235], v[248:251], v[8:11], 0
    v_mfma_f32_16x16x32_bf16 v[236:239], v[248:251], v[12:15], 0
    ds_read_b128 v[248:251], v4 offset:13312
    s_waitcnt vmcnt(6)
    v_mfma_f32_16x16x32_bf16 v[184:187], v[56:59], v[16:19], v[184:187]
    v_mfma_f32_16x16x32_bf16 v[188:191], v[56:59], v[20:23], v[188:191]
    ds_read_b128 v[56:59], v4 offset:14336
    s_waitcnt lgkmcnt(3)
    v_mfma_f32_16x16x32_bf16 v[192:195], v[60:63], v[16:19], v[192:195]
    v_mfma_f32_16x16x32_bf16 v[196:199], v[60:63], v[20:23], v[196:199]
    ds_read_b128 v[60:63], v4 offset:15360
    buffer_load_dwordx4 v[48:51], v1, s[8:11], s32 offen offset:1024 sc1
    buffer_load_dwordx4 v[52:55], v1, s[8:11], s33 offen offset:1024 sc1
    v_mfma_f32_16x16x32_bf16 v[200:203], v[64:67], v[16:19], v[200:203]
    v_mfma_f32_16x16x32_bf16 v[204:207], v[64:67], v[20:23], v[204:207]
    ds_read_b128 v[64:67], v4 offset:16384
    v_mfma_f32_16x16x32_bf16 v[208:211], v[68:71], v[16:19], v[208:211]
    v_mfma_f32_16x16x32_bf16 v[212:215], v[68:71], v[20:23], v[212:215]
    ds_read_b128 v[68:71], v4 offset:17408
    s_xor_b32 s31, s3, s21
    s_and_b32 s31, s31, 3
    s_cmp_eq_u32 s31, 0
    s_cbranch_scc0 NOSTD_79
    v_lshrrev_b32 v2, 4, v0
    v_lshlrev_b32 v2, 14, v2
    v_and_b32 v3, 15, v0
    v_lshl_add_u32 v2, v3, 4, v2
    s_lshl_b32 s34, s30, 8
    s_add_u32 s34, s34, 7864320
    s_lshr_b32 s31, s3, 2
    s_lshl_b32 s31, s31, 13
    s_add_u32 m0, s31, 114688
    s_add_u32 s35, s34, 0
    buffer_load_dwordx4 v2, s[8:11], s35 offen sc1 lds
    s_add_u32 m0, s31, 115712
    s_add_u32 s35, s34, 65536
    buffer_load_dwordx4 v2, s[8:11], s35 offen sc1 lds
    s_add_u32 m0, s31, 116736
    s_add_u32 s35, s34, 131072
    buffer_load_dwordx4 v2, s[8:11], s35 offen sc1 lds
    s_add_u32 m0, s31, 117760
    s_add_u32 s35, s34, 196608
    buffer_load_dwordx4 v2, s[8:11], s35 offen sc1 lds
    s_add_u32 m0, s31, 118784
    s_add_u32 s35, s34, 262144
    buffer_load_dwordx4 v2, s[8:11], s35 offen sc1 lds
    s_add_u32 m0, s31, 119808
    s_add_u32 s35, s34, 327680
    buffer_load_dwordx4 v2, s[8:11], s35 offen sc1 lds
    s_add_u32 m0, s31, 120832
    s_add_u32 s35, s34, 393216
    buffer_load_dwordx4 v2, s[8:11], s35 offen sc1 lds
    s_add_u32 m0, s31, 121856
    s_add_u32 s35, s34, 458752
    buffer_load_dwordx4 v2, s[8:11], s35 offen sc1 lds
NOSTD_79:
    v_mfma_f32_16x16x32_bf16 v[216:219], v[240:243], v[16:19], v[216:219]
    v_mfma_f32_16x16x32_bf16 v[220:223], v[240:243], v[20:23], v[220:223]
    ds_read_b128 v[240:243], v4 offset:18432
    s_waitcnt lgkmcnt(3)
    v_mfma_f32_16x16x32_bf16 v[224:227], v[244:247], v[16:19], v[224:227]
    v_mfma_f32_16x16x32_bf16 v[228:231], v[244:247], v[20:23], v[228:231]
    ds_read_b128 v[244:247], v4 offset:19456
    v_mfma_f32_16x16x32_bf16 v[232:235], v[248:251], v[16:19], v[232:235]
    v_mfma_f32_16x16x32_bf16 v[236:239], v[248:251], v[20:23], v[236:239]
    ds_read_b128 v[248:251], v4 offset:20480
    s_waitcnt vmcnt(6)
    v_mfma_f32_16x16x32_bf16 v[184:187], v[56:59], v[24:27], v[184:187]
    v_mfma_f32_16x16x32_bf16 v[188:191], v[56:59], v[28:31], v[188:191]
    ds_read_b128 v[56:59], v4 offset:21504
    v_mfma_f32_16x16x32_bf16 v[192:195], v[60:63], v[24:27], v[192:195]
    v_mfma_f32_16x16x32_bf16 v[196:199], v[60:63], v[28:31], v[196:199]
    ds_read_b128 v[60:63], v4 offset:22528
    buffer_load_dwordx4 v[8:11], v1, s[8:11], s32 offen offset:2048 sc1
    buffer_load_dwordx4 v[12:15], v1, s[8:11], s33 offen offset:2048 sc1
    s_waitcnt lgkmcnt(3)
    v_mfma_f32_16x16x32_bf16 v[200:203], v[64:67], v[24:27], v[200:203]
    v_mfma_f32_16x16x32_bf16 v[204:207], v[64:67], v[28:31], v[204:207]
    ds_read_b128 v[64:67], v4 offset:23552
    v_mfma_f32_16x16x32_bf16 v[208:211], v[68:71], v[24:27], v[208:211]
    v_mfma_f32_16x16x32_bf16 v[212:215], v[68:71], v[28:31], v[212:215]
    ds_read_b128 v[68:71], v4 offset:24576
    v_mfma_f32_16x16x32_bf16 v[216:219], v[240:243], v[24:27], v[216:219]
    v_mfma_f32_16x16x32_bf16 v[220:223], v[240:243], v[28:31], v[220:223]
    ds_read_b128 v[240:243], v4 offset:25600
    v_mfma_f32_16x16x32_bf16 v[224:227], v[244:247], v[24:27], v[224:227]
    v_mfma_f32_16x16x32_bf16 v[228:231], v[244:247], v[28:31], v[228:231]
    ds_read_b128 v[244:247], v4 offset:26624
    s_waitcnt lgkmcnt(3)
    v_mfma_f32_16x16x32_bf16 v[232:235], v[248:251], v[24:27], v[232:235]
    v_mfma_f32_16x16x32_bf16 v[236:239], v[248:251], v[28:31], v[236:239]
    ds_read_b128 v[248:251], v4 offset:27648
    s_waitcnt vmcnt(6)
    v_mfma_f32_16x16x32_bf16 v[184:187], v[56:59], v[32:35], v[184:187]
    v_mfma_f32_16x16x32_bf16 v[188:191], v[56:59], v[36:39], v[188:191]
    ds_read_b128 v[56:59], v4 offset:28672
    v_mfma_f32_16x16x32_bf16 v[192:195], v[60:63], v[32:35], v[192:195]
    v_mfma_f32_16x16x32_bf16 v[196:199], v[60:63], v[36:39], v[196:199]
    ds_read_b128 v[60:63], v4 offset:29696
    buffer_load_dwordx4 v[16:19], v1, s[8:11], s32 offen offset:3072 sc1
    buffer_load_dwordx4 v[20:23], v1, s[8:11], s33 offen offset:3072 sc1
    v_mfma_f32_16x16x32_bf16 v[200:203], v[64:67], v[32:35], v[200:203]
    v_mfma_f32_16x16x32_bf16 v[204:207], v[64:67], v[36:39], v[204:207]
    ds_read_b128 v[64:67], v4 offset:30720
    s_waitcnt lgkmcnt(3)
    v_mfma_f32_16x16x32_bf16 v[208:211], v[68:71], v[32:35], v[208:211]
    v_mfma_f32_16x16x32_bf16 v[212:215], v[68:71], v[36:39], v[212:215]
    ds_read_b128 v[68:71], v4 offset:31744
    v_mfma_f32_16x16x32_bf16 v[216:219], v[240:243], v[32:35], v[216:219]
    v_mfma_f32_16x16x32_bf16 v[220:223], v[240:243], v[36:39], v[220:223]
    ds_read_b128 v[240:243], v4 offset:32768
    v_mfma_f32_16x16x32_bf16 v[224:227], v[244:247], v[32:35], v[224:227]
    v_mfma_f32_16x16x32_bf16 v[228:231], v[244:247], v[36:39], v[228:231]
    ds_read_b128 v[244:247], v4 offset:33792
    v_mfma_f32_16x16x32_bf16 v[232:235], v[248:251], v[32:35], v[232:235]
    v_mfma_f32_16x16x32_bf16 v[236:239], v[248:251], v[36:39], v[236:239]
    ds_read_b128 v[248:251], v4 offset:34816
    s_waitcnt vmcnt(6) lgkmcnt(3)
    v_mfma_f32_16x16x32_bf16 v[184:187], v[56:59], v[40:43], v[184:187]
    v_mfma_f32_16x16x32_bf16 v[188:191], v[56:59], v[44:47], v[188:191]
    ds_read_b128 v[56:59], v4 offset:35840
    v_mfma_f32_16x16x32_bf16 v[192:195], v[60:63], v[40:43], v[192:195]
    v_mfma_f32_16x16x32_bf16 v[196:199], v[60:63], v[44:47], v[196:199]
    ds_read_b128 v[60:63], v4 offset:36864
    s_add_u32 s32, s32, 4096
    s_add_u32 s33, s33, 4096
    buffer_load_dwordx4 v[24:27], v1, s[8:11], s32 offen offset:0 sc1
    buffer_load_dwordx4 v[28:31], v1, s[8:11], s33 offen offset:0 sc1
    v_mfma_f32_16x16x32_bf16 v[200:203], v[64:67], v[40:43], v[200:203]
    v_mfma_f32_16x16x32_bf16 v[204:207], v[64:67], v[44:47], v[204:207]
    ds_read_b128 v[64:67], v4 offset:37888
    v_mfma_f32_16x16x32_bf16 v[208:211], v[68:71], v[40:43], v[208:211]
    v_mfma_f32_16x16x32_bf16 v[212:215], v[68:71], v[44:47], v[212:215]
    ds_read_b128 v[68:71], v4 offset:38912
    s_lshl_b32 s36, s23, 3
    s_add_u32 s36, s36, s3
    s_lshl_b32 s36, s36, 11
    buffer_load_dwordx4 v[252:255], v1, s[8:11], s36 offen offset:0
    s_waitcnt lgkmcnt(3)
    v_mfma_f32_16x16x32_bf16 v[216:219], v[240:243], v[40:43], v[216:219]
    v_mfma_f32_16x16x32_bf16 v[220:223], v[240:243], v[44:47], v[220:223]
    ds_read_b128 v[240:243], v4 offset:39936
    v_mfma_f32_16x16x32_bf16 v[224:227], v[244:247], v[40:43], v[224:227]
    v_mfma_f32_16x16x32_bf16 v[228:231], v[244:247], v[44:47], v[228:231]
    ds_read_b128 v[244:247], v4 offset:40960
    v_mfma_f32_16x16x32_bf16 v[232:235], v[248:251], v[40:43], v[232:235]
    v_mfma_f32_16x16x32_bf16 v[236:239], v[248:251], v[44:47], v[236:239]
    ds_read_b128 v[248:251], v4 offset:41984
    s_setprio 2
    s_waitcnt vmcnt(7)
    v_mfma_f32_16x16x32_bf16 v[184:187], v[56:59], v[48:51], v[184:187]
    v_mfma_f32_16x16x32_bf16 v[188:191], v[56:59], v[52:55], v[188:191]
    ds_read_b128 v[56:59], v4 offset:43008
    s_waitcnt lgkmcnt(3)
    v_mfma_f32_16x16x32_bf16 v[192:195], v[60:63], v[48:51], v[192:195]
    v_mfma_f32_16x16x32_bf16 v[196:199], v[60:63], v[52:55], v[196:199]
    ds_read_b128 v[60:63], v4 offset:44032
    buffer_load_dwordx4 v[32:35], v1, s[8:11], s32 offen offset:1024 sc1
    buffer_load_dwordx4 v[36:39], v1, s[8:11], s33 offen offset:1024 sc1
    v_mfma_f32_16x16x32_bf16 v[200:203], v[64:67], v[48:51], v[200:203]
    v_mfma_f32_16x16x32_bf16 v[204:207], v[64:67], v[52:55], v[204:207]
    ds_read_b128 v[64:67], v4 offset:45056
    v_mfma_f32_16x16x32_bf16 v[208:211], v[68:71], v[48:51], v[208:211]
    v_mfma_f32_16x16x32_bf16 v[212:215], v[68:71], v[52:55], v[212:215]
    ds_read_b128 v[68:71], v4 offset:46080
    v_mfma_f32_16x16x32_bf16 v[216:219], v[240:243], v[48:51], v[216:219]
    v_mfma_f32_16x16x32_bf16 v[220:223], v[240:243], v[52:55], v[220:223]
    ds_read_b128 v[240:243], v4 offset:47104
    s_waitcnt lgkmcnt(3)
    v_mfma_f32_16x16x32_bf16 v[224:227], v[244:247], v[48:51], v[224:227]
    v_mfma_f32_16x16x32_bf16 v[228:231], v[244:247], v[52:55], v[228:231]
    ds_read_b128 v[244:247], v4 offset:48128
    v_mfma_f32_16x16x32_bf16 v[232:235], v[248:251], v[48:51], v[232:235]
    v_mfma_f32_16x16x32_bf16 v[236:239], v[248:251], v[52:55], v[236:239]
    ds_read_b128 v[248:251], v4 offset:49152
    s_waitcnt vmcnt(7)
    v_mfma_f32_16x16x32_bf16 v[184:187], v[56:59], v[8:11], v[184:187]
    v_mfma_f32_16x16x32_bf16 v[188:191], v[56:59], v[12:15], v[188:191]
    ds_read_b128 v[56:59], v4 offset:50176
    v_mfma_f32_16x16x32_bf16 v[192:195], v[60:63], v[8:11], v[192:195]
    v_mfma_f32_16x16x32_bf16 v[196:199], v[60:63], v[12:15], v[196:199]
    ds_read_b128 v[60:63], v4 offset:51200
    buffer_load_dwordx4 v[40:43], v1, s[8:11], s32 offen offset:2048 sc1
    buffer_load_dwordx4 v[44:47], v1, s[8:11], s33 offen offset:2048 sc1
    s_waitcnt lgkmcnt(3)
    v_mfma_f32_16x16x32_bf16 v[200:203], v[64:67], v[8:11], v[200:203]
    v_mfma_f32_16x16x32_bf16 v[204:207], v[64:67], v[12:15], v[204:207]
    ds_read_b128 v[64:67], v4 offset:52224
    v_mfma_f32_16x16x32_bf16 v[208:211], v[68:71], v[8:11], v[208:211]
    v_mfma_f32_16x16x32_bf16 v[212:215], v[68:71], v[12:15], v[212:215]
    ds_read_b128 v[68:71], v4 offset:53248
    buffer_load_dwordx4 v[252:255], v1, s[8:11], s36 offen offset:1024
    v_mfma_f32_16x16x32_bf16 v[216:219], v[240:243], v[8:11], v[216:219]
    v_mfma_f32_16x16x32_bf16 v[220:223], v[240:243], v[12:15], v[220:223]
    ds_read_b128 v[240:243], v4 offset:54272
    v_mfma_f32_16x16x32_bf16 v[224:227], v[244:247], v[8:11], v[224:227]
    v_mfma_f32_16x16x32_bf16 v[228:231], v[244:247], v[12:15], v[228:231]
    ds_read_b128 v[244:247], v4 offset:55296
    s_waitcnt lgkmcnt(3)
    v_mfma_f32_16x16x32_bf16 v[232:235], v[248:251], v[8:11], v[232:235]
    v_mfma_f32_16x16x32_bf16 v[236:239], v[248:251], v[12:15], v[236:239]
    ds_read_b128 v[248:251], v4 offset:56320
    s_waitcnt vmcnt(8)
    v_mfma_f32_16x16x32_bf16 v[184:187], v[56:59], v[16:19], v[184:187]
    v_mfma_f32_16x16x32_bf16 v[188:191], v[56:59], v[20:23], v[188:191]
    ds_read_b128 v[56:59], v4 offset:57344
    v_mfma_f32_16x16x32_bf16 v[192:195], v[60:63], v[16:19], v[192:195]
    v_mfma_f32_16x16x32_bf16 v[196:199], v[60:63], v[20:23], v[196:199]
    ds_read_b128 v[60:63], v4 offset:58368
    buffer_load_dwordx4 v[48:51], v1, s[8:11], s32 offen offset:3072 sc1
    buffer_load_dwordx4 v[52:55], v1, s[8:11], s33 offen offset:3072 sc1
    v_mfma_f32_16x16x32_bf16 v[200:203], v[64:67], v[16:19], v[200:203]
    v_mfma_f32_16x16x32_bf16 v[204:207], v[64:67], v[20:23], v[204:207]
    ds_read_b128 v[64:67], v4 offset:59392
    s_waitcnt lgkmcnt(3)
    v_mfma_f32_16x16x32_bf16 v[208:211], v[68:71], v[16:19], v[208:211]
    v_mfma_f32_16x16x32_bf16 v[212:215], v[68:71], v[20:23], v[212:215]
    ds_read_b128 v[68:71], v4 offset:60416
    v_mfma_f32_16x16x32_bf16 v[216:219], v[240:243], v[16:19], v[216:219]
    v_mfma_f32_16x16x32_bf16 v[220:223], v[240:243], v[20:23], v[220:223]
    ds_read_b128 v[240:243], v4 offset:61440
    v_mfma_f32_16x16x32_bf16 v[224:227], v[244:247], v[16:19], v[224:227]
    v_mfma_f32_16x16x32_bf16 v[228:231], v[244:247], v[20:23], v[228:231]
    ds_read_b128 v[244:247], v4 offset:62464
    v_mfma_f32_16x16x32_bf16 v[232:235], v[248:251], v[16:19], v[232:235]
    v_mfma_f32_16x16x32_bf16 v[236:239], v[248:251], v[20:23], v[236:239]
    ds_read_b128 v[248:251], v4 offset:63488
    s_waitcnt vmcnt(8) lgkmcnt(3)
    v_mfma_f32_16x16x32_bf16 v[184:187], v[56:59], v[24:27], v[184:187]
    v_mfma_f32_16x16x32_bf16 v[188:191], v[56:59], v[28:31], v[188:191]
    ds_read_b128 v[56:59], v4 offset:64512
    v_mfma_f32_16x16x32_bf16 v[192:195], v[60:63], v[24:27], v[192:195]
    v_mfma_f32_16x16x32_bf16 v[196:199], v[60:63], v[28:31], v[196:199]
    ds_read_b128 v[60:63], v5 offset:0
    s_add_u32 s32, s32, 4096
    s_add_u32 s33, s33, 4096
    buffer_load_dwordx4 v[8:11], v1, s[8:11], s32 offen offset:0 sc1
    buffer_load_dwordx4 v[12:15], v1, s[8:11], s33 offen offset:0 sc1
    v_mfma_f32_16x16x32_bf16 v[200:203], v[64:67], v[24:27], v[200:203]
    v_mfma_f32_16x16x32_bf16 v[204:207], v[64:67], v[28:31], v[204:207]
    ds_read_b128 v[64:67], v5 offset:1024
    v_mfma_f32_16x16x32_bf16 v[208:211], v[68:71], v[24:27], v[208:211]
    v_mfma_f32_16x16x32_bf16 v[212:215], v[68:71], v[28:31], v[212:215]
    ds_read_b128 v[68:71], v5 offset:2048
    s_waitcnt lgkmcnt(3)
    v_mfma_f32_16x16x32_bf16 v[216:219], v[240:243], v[24:27], v[216:219]
    v_mfma_f32_16x16x32_bf16 v[220:223], v[240:243], v[28:31], v[220:223]
    ds_read_b128 v[240:243], v5 offset:3072
    v_mfma_f32_16x16x32_bf16 v[224:227], v[244:247], v[24:27], v[224:227]
    v_mfma_f32_16x16x32_bf16 v[228:231], v[244:247], v[28:31], v[228:231]
    ds_read_b128 v[244:247], v5 offset:4096
    v_mfma_f32_16x16x32_bf16 v[232:235], v[248:251], v[24:27], v[232:235]
    v_mfma_f32_16x16x32_bf16 v[236:239], v[248:251], v[28:31], v[236:239]
    ds_read_b128 v[248:251], v5 offset:5120
    s_waitcnt vmcnt(7)
    v_mfma_f32_16x16x32_bf16 v[184:187], v[56:59], v[32:35], v[184:187]
    v_mfma_f32_16x16x32_bf16 v[188:191], v[56:59], v[36:39], v[188:191]
    ds_read_b128 v[56:59], v5 offset:6144
    s_waitcnt lgkmcnt(3)
    v_mfma_f32_16x16x32_bf16 v[192:195], v[60:63], v[32:35], v[192:195]
    v_mfma_f32_16x16x32_bf16 v[196:199], v[60:63], v[36:39], v[196:199]
    ds_read_b128 v[60:63], v5 offset:7168
    buffer_load_dwordx4 v[16:19], v1, s[8:11], s32 offen offset:1024 sc1
    buffer_load_dwordx4 v[20:23], v1, s[8:11], s33 offen offset:1024 sc1
    v_mfma_f32_16x16x32_bf16 v[200:203], v[64:67], v[32:35], v[200:203]
    v_mfma_f32_16x16x32_bf16 v[204:207], v[64:67], v[36:39], v[204:207]
    ds_read_b128 v[64:67], v5 offset:8192
    v_mfma_f32_16x16x32_bf16 v[208:211], v[68:71], v[32:35], v[208:211]
    v_mfma_f32_16x16x32_bf16 v[212:215], v[68:71], v[36:39], v[212:215]
    ds_read_b128 v[68:71], v5 offset:9216
    v_mfma_f32_16x16x32_bf16 v[216:219], v[240:243], v[32:35], v[216:219]
    v_mfma_f32_16x16x32_bf16 v[220:223], v[240:243], v[36:39], v[220:223]
    ds_read_b128 v[240:243], v5 offset:10240
    s_waitcnt lgkmcnt(3)
    v_mfma_f32_16x16x32_bf16 v[224:227], v[244:247], v[32:35], v[224:227]
    v_mfma_f32_16x16x32_bf16 v[228:231], v[244:247], v[36:39], v[228:231]
    ds_read_b128 v[244:247], v5 offset:11264
    v_mfma_f32_16x16x32_bf16 v[232:235], v[248:251], v[32:35], v[232:235]
    v_mfma_f32_16x16x32_bf16 v[236:239], v[248:251], v[36:39], v[236:239]
    ds_read_b128 v[248:251], v5 offset:12288
    s_setprio 1
    s_waitcnt vmcnt(7)
    v_mfma_f32_16x16x32_bf16 v[184:187], v[56:59], v[40:43], v[184:187]
    v_mfma_f32_16x16x32_bf16 v[188:191], v[56:59], v[44:47], v[188:191]
    ds_read_b128 v[56:59], v5 offset:13312
    v_mfma_f32_16x16x32_bf16 v[192:195], v[60:63], v[40:43], v[192:195]
    v_mfma_f32_16x16x32_bf16 v[196:199], v[60:63], v[44:47], v[196:199]
    ds_read_b128 v[60:63], v5 offset:14336
    buffer_load_dwordx4 v[24:27], v1, s[8:11], s32 offen offset:2048 sc1
    buffer_load_dwordx4 v[28:31], v1, s[8:11], s33 offen offset:2048 sc1
    s_waitcnt lgkmcnt(3)
    v_mfma_f32_16x16x32_bf16 v[200:203], v[64:67], v[40:43], v[200:203]
    v_mfma_f32_16x16x32_bf16 v[204:207], v[64:67], v[44:47], v[204:207]
    ds_read_b128 v[64:67], v5 offset:15360
    v_mfma_f32_16x16x32_bf16 v[208:211], v[68:71], v[40:43], v[208:211]
    v_mfma_f32_16x16x32_bf16 v[212:215], v[68:71], v[44:47], v[212:215]
    ds_read_b128 v[68:71], v5 offset:16384
    v_mfma_f32_16x16x32_bf16 v[216:219], v[240:243], v[40:43], v[216:219]
    v_mfma_f32_16x16x32_bf16 v[220:223], v[240:243], v[44:47], v[220:223]
    ds_read_b128 v[240:243], v5 offset:17408
    v_mfma_f32_16x16x32_bf16 v[224:227], v[244:247], v[40:43], v[224:227]
    v_mfma_f32_16x16x32_bf16 v[228:231], v[244:247], v[44:47], v[228:231]
    ds_read_b128 v[244:247], v5 offset:18432
    s_waitcnt lgkmcnt(3)
    v_mfma_f32_16x16x32_bf16 v[232:235], v[248:251], v[40:43], v[232:235]
    v_mfma_f32_16x16x32_bf16 v[236:239], v[248:251], v[44:47], v[236:239]
    ds_read_b128 v[248:251], v5 offset:19456
    s_waitcnt vmcnt(6)
    v_mfma_f32_16x16x32_bf16 v[184:187], v[56:59], v[48:51], v[184:187]
    v_mfma_f32_16x16x32_bf16 v[188:191], v[56:59], v[52:55], v[188:191]
    ds_read_b128 v[56:59], v5 offset:20480
    v_mfma_f32_16x16x32_bf16 v[192:195], v[60:63], v[48:51], v[192:195]
    v_mfma_f32_16x16x32_bf16 v[196:199], v[60:63], v[52:55], v[196:199]
    ds_read_b128 v[60:63], v5 offset:21504
    buffer_load_dwordx4 v[32:35], v1, s[8:11], s32 offen offset:3072 sc1
    buffer_load_dwordx4 v[36:39], v1, s[8:11], s33 offen offset:3072 sc1
    v_mfma_f32_16x16x32_bf16 v[200:203], v[64:67], v[48:51], v[200:203]
    v_mfma_f32_16x16x32_bf16 v[204:207], v[64:67], v[52:55], v[204:207]
    ds_read_b128 v[64:67], v5 offset:22528
    s_waitcnt lgkmcnt(3)
    v_mfma_f32_16x16x32_bf16 v[208:211], v[68:71], v[48:51], v[208:211]
    v_mfma_f32_16x16x32_bf16 v[212:215], v[68:71], v[52:55], v[212:215]
    ds_read_b128 v[68:71], v5 offset:23552
    v_mfma_f32_16x16x32_bf16 v[216:219], v[240:243], v[48:51], v[216:219]
    v_mfma_f32_16x16x32_bf16 v[220:223], v[240:243], v[52:55], v[220:223]
    ds_read_b128 v[240:243], v5 offset:24576
    v_mfma_f32_16x16x32_bf16 v[224:227], v[244:247], v[48:51], v[224:227]
    v_mfma_f32_16x16x32_bf16 v[228:231], v[244:247], v[52:55], v[228:231]
    ds_read_b128 v[244:247], v5 offset:25600
    v_mfma_f32_16x16x32_bf16 v[232:235], v[248:251], v[48:51], v[232:235]
    v_mfma_f32_16x16x32_bf16 v[236:239], v[248:251], v[52:55], v[236:239]
    ds_read_b128 v[248:251], v5 offset:26624
    s_waitcnt vmcnt(6) lgkmcnt(3)
    v_mfma_f32_16x16x32_bf16 v[184:187], v[56:59], v[8:11], v[184:187]
    v_mfma_f32_16x16x32_bf16 v[188:191], v[56:59], v[12:15], v[188:191]
    ds_read_b128 v[56:59], v5 offset:27648
    v_mfma_f32_16x16x32_bf16 v[192:195], v[60:63], v[8:11], v[192:195]
    v_mfma_f32_16x16x32_bf16 v[196:199], v[60:63], v[12:15], v[196:199]
    ds_read_b128 v[60:63], v5 offset:28672
    s_add_u32 s44, s44, 4096
    buffer_load_dwordx4 v[152:155], v1, s[8:11], s44 offen offset:0
    v_mfma_f32_16x16x32_bf16 v[200:203], v[64:67], v[8:11], v[200:203]
    v_mfma_f32_16x16x32_bf16 v[204:207], v[64:67], v[12:15], v[204:207]
    ds_read_b128 v[64:67], v5 offset:29696
    v_mfma_f32_16x16x32_bf16 v[208:211], v[68:71], v[8:11], v[208:211]
    v_mfma_f32_16x16x32_bf16 v[212:215], v[68:71], v[12:15], v[212:215]
    ds_read_b128 v[68:71], v5 offset:30720
    buffer_load_dwordx4 v[156:159], v1, s[8:11], s44 offen offset:1024
    s_waitcnt lgkmcnt(3)
    v_mfma_f32_16x16x32_bf16 v[216:219], v[240:243], v[8:11], v[216:219]
    v_mfma_f32_16x16x32_bf16 v[220:223], v[240:243], v[12:15], v[220:223]
    ds_read_b128 v[240:243], v5 offset:31744
    v_mfma_f32_16x16x32_bf16 v[224:227], v[244:247], v[8:11], v[224:227]
    v_mfma_f32_16x16x32_bf16 v[228:231], v[244:247], v[12:15], v[228:231]
    ds_read_b128 v[244:247], v5 offset:32768
    v_mfma_f32_16x16x32_bf16 v[232:235], v[248:251], v[8:11], v[232:235]
    v_mfma_f32_16x16x32_bf16 v[236:239], v[248:251], v[12:15], v[236:239]
    ds_read_b128 v[248:251], v5 offset:33792
    s_waitcnt vmcnt(6)
    v_mfma_f32_16x16x32_bf16 v[184:187], v[56:59], v[16:19], v[184:187]
    v_mfma_f32_16x16x32_bf16 v[188:191], v[56:59], v[20:23], v[188:191]
    ds_read_b128 v[56:59], v5 offset:34816
    s_waitcnt lgkmcnt(3)
    v_mfma_f32_16x16x32_bf16 v[192:195], v[60:63], v[16:19], v[192:195]
    v_mfma_f32_16x16x32_bf16 v[196:199], v[60:63], v[20:23], v[196:199]
    ds_read_b128 v[60:63], v5 offset:35840
    buffer_load_dwordx4 v[160:163], v1, s[8:11], s44 offen offset:2048
    v_mfma_f32_16x16x32_bf16 v[200:203], v[64:67], v[16:19], v[200:203]
    v_mfma_f32_16x16x32_bf16 v[204:207], v[64:67], v[20:23], v[204:207]
    ds_read_b128 v[64:67], v5 offset:36864
    v_mfma_f32_16x16x32_bf16 v[208:211], v[68:71], v[16:19], v[208:211]
    v_mfma_f32_16x16x32_bf16 v[212:215], v[68:71], v[20:23], v[212:215]
    ds_read_b128 v[68:71], v5 offset:37888
    buffer_load_dwordx4 v[164:167], v1, s[8:11], s44 offen offset:3072
    v_mfma_f32_16x16x32_bf16 v[216:219], v[240:243], v[16:19], v[216:219]
    v_mfma_f32_16x16x32_bf16 v[220:223], v[240:243], v[20:23], v[220:223]
    ds_read_b128 v[240:243], v5 offset:38912
    s_waitcnt lgkmcnt(3)
    v_mfma_f32_16x16x32_bf16 v[224:227], v[244:247], v[16:19], v[224:227]
    v_mfma_f32_16x16x32_bf16 v[228:231], v[244:247], v[20:23], v[228:231]
    ds_read_b128 v[244:247], v5 offset:39936
    v_mfma_f32_16x16x32_bf16 v[232:235], v[248:251], v[16:19], v[232:235]
    v_mfma_f32_16x16x32_bf16 v[236:239], v[248:251], v[20:23], v[236:239]
    ds_read_b128 v[248:251], v5 offset:40960
    s_setprio 0
    s_waitcnt vmcnt(6)
    v_mfma_f32_16x16x32_bf16 v[184:187], v[56:59], v[24:27], v[184:187]
    v_mfma_f32_16x16x32_bf16 v[188:191], v[56:59], v[28:31], v[188:191]
    ds_read_b128 v[56:59], v5 offset:41984
    v_mfma_f32_16x16x32_bf16 v[192:195], v[60:63], v[24:27], v[192:195]
    v_mfma_f32_16x16x32_bf16 v[196:199], v[60:63], v[28:31], v[196:199]
    ds_read_b128 v[60:63], v5 offset:43008
    s_add_u32 s44, s44, 4096
    buffer_load_dwordx4 v[168:171], v1, s[8:11], s44 offen offset:0
    s_waitcnt lgkmcnt(3)
    v_mfma_f32_16x16x32_bf16 v[200:203], v[64:67], v[24:27], v[200:203]
    v_mfma_f32_16x16x32_bf16 v[204:207], v[64:67], v[28:31], v[204:207]
    ds_read_b128 v[64:67], v5 offset:44032
    v_mfma_f32_16x16x32_bf16 v[208:211], v[68:71], v[24:27], v[208:211]
    v_mfma_f32_16x16x32_bf16 v[212:215], v[68:71], v[28:31], v[212:215]
    ds_read_b128 v[68:71], v5 offset:45056
    buffer_load_dwordx4 v[172:175], v1, s[8:11], s44 offen offset:1024
    v_mfma_f32_16x16x32_bf16 v[216:219], v[240:243], v[24:27], v[216:219]
    v_mfma_f32_16x16x32_bf16 v[220:223], v[240:243], v[28:31], v[220:223]
    ds_read_b128 v[240:243], v5 offset:46080
    v_mfma_f32_16x16x32_bf16 v[224:227], v[244:247], v[24:27], v[224:227]
    v_mfma_f32_16x16x32_bf16 v[228:231], v[244:247], v[28:31], v[228:231]
    ds_read_b128 v[244:247], v5 offset:47104
    s_waitcnt lgkmcnt(3)
    v_mfma_f32_16x16x32_bf16 v[232:235], v[248:251], v[24:27], v[232:235]
    v_mfma_f32_16x16x32_bf16 v[236:239], v[248:251], v[28:31], v[236:239]
    ds_read_b128 v[248:251], v5 offset:48128
    s_waitcnt vmcnt(6)
    v_mfma_f32_16x16x32_bf16 v[184:187], v[56:59], v[32:35], v[184:187]
    v_mfma_f32_16x16x32_bf16 v[188:191], v[56:59], v[36:39], v[188:191]
    v_mfma_f32_16x16x32_bf16 v[192:195], v[60:63], v[32:35], v[192:195]
    v_mfma_f32_16x16x32_bf16 v[196:199], v[60:63], v[36:39], v[196:199]
    buffer_load_dwordx4 v[176:179], v1, s[8:11], s44 offen offset:2048
    v_mfma_f32_16x16x32_bf16 v[200:203], v[64:67], v[32:35], v[200:203]
    v_mfma_f32_16x16x32_bf16 v[204:207], v[64:67], v[36:39], v[204:207]
    s_waitcnt lgkmcnt(3)
    v_mfma_f32_16x16x32_bf16 v[208:211], v[68:71], v[32:35], v[208:211]
    v_mfma_f32_16x16x32_bf16 v[212:215], v[68:71], v[36:39], v[212:215]
    buffer_load_dwordx4 v[180:183], v1, s[8:11], s44 offen offset:3072
    s_waitcnt lgkmcnt(2)
    v_mfma_f32_16x16x32_bf16 v[216:219], v[240:243], v[32:35], v[216:219]
    v_mfma_f32_16x16x32_bf16 v[220:223], v[240:243], v[36:39], v[220:223]
    s_waitcnt lgkmcnt(1)
    v_mfma_f32_16x16x32_bf16 v[224:227], v[244:247], v[32:35], v[224:227]
    v_mfma_f32_16x16x32_bf16 v[228:231], v[244:247], v[36:39], v[228:231]
    v_max_f32 v184, 0, v184
    v_max_f32 v185, 0, v185
    v_pk_mul_f32 v[184:185], v[184:185], v[186:187]
    v_cvt_pk_bf16_f32 v56, v184, v185
    v_max_f32 v192, 0, v192
    v_max_f32 v193, 0, v193
    v_pk_mul_f32 v[192:193], v[192:193], v[194:195]
    v_cvt_pk_bf16_f32 v57, v192, v193
    v_max_f32 v200, 0, v200
    v_max_f32 v201, 0, v201
    v_pk_mul_f32 v[200:201], v[200:201], v[202:203]
    v_cvt_pk_bf16_f32 v58, v200, v201
    v_max_f32 v208, 0, v208
    v_max_f32 v209, 0, v209
    v_pk_mul_f32 v[208:209], v[208:209], v[210:211]
    v_cvt_pk_bf16_f32 v59, v208, v209
    buffer_store_dwordx4 v[56:59], v1, s[8:11], s38 offen offset:0 sc1
    s_waitcnt lgkmcnt(0)
    v_mfma_f32_16x16x32_bf16 v[232:235], v[248:251], v[32:35], v[232:235]
    v_mfma_f32_16x16x32_bf16 v[236:239], v[248:251], v[36:39], v[236:239]
    v_max_f32 v188, 0, v188
    v_max_f32 v189, 0, v189
    v_pk_mul_f32 v[188:189], v[188:189], v[190:191]
    v_cvt_pk_bf16_f32 v60, v188, v189
    v_max_f32 v196, 0, v196
    v_max_f32 v197, 0, v197
    v_pk_mul_f32 v[196:197], v[196:197], v[198:199]
    v_cvt_pk_bf16_f32 v61, v196, v197
    v_max_f32 v204, 0, v204
    v_max_f32 v205, 0, v205
    v_pk_mul_f32 v[204:205], v[204:205], v[206:207]
    v_cvt_pk_bf16_f32 v62, v204, v205
    v_max_f32 v212, 0, v212
    v_max_f32 v213, 0, v213
    v_pk_mul_f32 v[212:213], v[212:213], v[214:215]
    v_cvt_pk_bf16_f32 v63, v212, v213
    buffer_store_dwordx4 v[60:63], v1, s[8:11], s38 offen offset:1024 sc1
    s_setprio 0
    s_nop 3
    v_max_f32 v216, 0, v216
    v_max_f32 v217, 0, v217
    v_pk_mul_f32 v[216:217], v[216:217], v[218:219]
    v_cvt_pk_bf16_f32 v64, v216, v217
    v_max_f32 v220, 0, v220
    v_max_f32 v221, 0, v221
    v_pk_mul_f32 v[220:221], v[220:221], v[222:223]
    v_cvt_pk_bf16_f32 v66, v220, v221
    v_max_f32 v224, 0, v224
    v_max_f32 v225, 0, v225
    v_pk_mul_f32 v[224:225], v[224:225], v[226:227]
    v_cvt_pk_bf16_f32 v65, v224, v225
    v_max_f32 v228, 0, v228
    v_max_f32 v229, 0, v229
    v_pk_mul_f32 v[228:229], v[228:229], v[230:231]
    v_cvt_pk_bf16_f32 v67, v228, v229
    buffer_store_dwordx4 v[64:67], v1, s[8:11], s38 offen offset:2048 sc1
    v_max_f32 v232, 0, v232
    v_max_f32 v233, 0, v233
    v_pk_mul_f32 v[232:233], v[232:233], v[234:235]
    v_cvt_pk_bf16_f32 v68, v232, v233
    v_max_f32 v236, 0, v236
    v_max_f32 v237, 0, v237
    v_pk_mul_f32 v[236:237], v[236:237], v[238:239]
    v_cvt_pk_bf16_f32 v69, v236, v237
    buffer_store_dwordx2 v[68:69], v6, s[8:11], s38 offen offset:3072 sc1
    s_add_u32 s30, s26, 3
    v_mov_b32 v254, s30
    v_mov_b32 v255, s25
    s_and_b32 s36, s21, 3
    s_lshl_b32 s30, s24, 5
    s_lshl_b32 s31, s3, 2
    s_add_u32 s30, s30, s31
    s_lshl_b32 s30, s30, 3
    s_add_u32 s30, s30, s36
    s_lshl_b32 s30, s30, 2
    s_add_u32 s30, s30, 7405568
    v_and_b32 v2, 3, v0
    v_lshl_add_u32 v2, v2, 5, s30
    v_add_u32 v252, 16, v2
    s_add_u32 s47, s26, 3
    s_lshl_b32 s32, s24, 3
    s_add_u32 s32, s32, s36
    s_lshl_b32 s32, s32, 5
    s_add_u32 s32, s32, s31
    s_mul_i32 s32, s32, 3584
    s_add_u32 s32, s32, 14680064
    s_add_u32 s33, s32, 3584
    s_add_u32 s34, s32, 7168
    s_add_u32 s35, s32, 10752
    s_lshl_b32 s37, s24, 4
    s_lshl_b32 s31, s36, 1
    s_add_u32 s37, s37, s31
    s_and_b32 s31, s3, 2
    s_lshl_b32 s31, s31, 2
    s_add_u32 s37, s37, s31
    s_and_b32 s31, s3, 1
    s_add_u32 s37, s37, s31
    s_lshl_b32 s38, s22, 1
    s_lshr_b32 s31, s3, 2
    s_add_u32 s38, s38, s31
    s_lshl_b32 s39, s37, 4
    s_add_u32 s39, s39, s38
    s_lshl_b32 s39, s39, 10
    s_add_u32 s40, s39, 12582912
    s_and_b32 s41, s3, 2
    s_lshl_b32 s41, s41, 12
    s_and_b32 s31, s3, 1
    s_lshl_b32 s31, s31, 7
    s_add_u32 s41, s41, s31
    s_add_u32 s41, s41, 114688
    v_and_b32 v6, 15, v0
    v_lshrrev_b32 v7, 4, v0
    v_lshlrev_b32 v5, 11, v7
    v_lshl_add_u32 v5, v6, 3, v5
    v_add_u32 v5, s41, v5
    v_lshlrev_b32 v253, 3, v0
    s_waitcnt vmcnt(0)
    s_mov_b64 exec, 1
    s_cmp_eq_u32 s93, 0
    s_cbranch_scc1 GST_80
    buffer_store_dword v254, v255, s[8:11], 0 offen
GSTB_81:
    s_mov_b64 exec, -1
    s_mov_b32 s46, 262144
POLL_82:
    buffer_load_dword v3, v2, s[8:11], 0 offen sc1
    s_waitcnt vmcnt(0)
    v_cmp_gt_u32 vcc, s47, v3
    s_cbranch_vccz POLLD_83
    s_sub_u32 s46, s46, 1
    s_cbranch_scc0 POLL_82
POLLD_83:
    buffer_load_dwordx4 v[8:11], v1, s[8:11], s32 offen offset:0 sc1
    buffer_load_dwordx4 v[12:15], v1, s[8:11], s32 offen offset:1024 sc1
    buffer_load_dwordx4 v[16:19], v1, s[8:11], s33 offen offset:0 sc1
    buffer_load_dwordx4 v[20:23], v1, s[8:11], s33 offen offset:1024 sc1
    buffer_load_dwordx4 v[24:27], v1, s[8:11], s34 offen offset:0 sc1
    buffer_load_dwordx4 v[28:31], v1, s[8:11], s34 offen offset:1024 sc1
    buffer_load_dwordx4 v[32:35], v1, s[8:11], s35 offen offset:0 sc1
    s_lshl_b32 s30, s3, 11
    v_add_u32 v2, s30, v1
    v_add_u32 v3, 65536, v2
    s_cmp_eq_u32 s3, 7
    s_cselect_b32 s30, 8, s3
    s_lshl_b32 s30, s30, 14
    v_add_u32 v4, s30, v1
    v_add_u32 v255, 16384, v3
    s_setprio 3
    s_waitcnt vmcnt(6)
    v_mfma_f32_16x16x32_bf16 v[184:187], v[72:75], v[8:11], 0
    v_mfma_f32_16x16x32_bf16 v[188:191], v[76:79], v[8:11], 0
    v_mfma_f32_16x16x32_bf16 v[192:195], v[80:83], v[8:11], 0
    v_mfma_f32_16x16x32_bf16 v[196:199], v[84:87], v[8:11], 0
    buffer_load_dwordx4 v[36:39], v1, s[8:11], s35 offen offset:1024 sc1
    s_waitcnt vmcnt(6)
    v_mfma_f32_16x16x32_bf16 v[200:203], v[72:75], v[12:15], 0
    v_mfma_f32_16x16x32_bf16 v[204:207], v[76:79], v[12:15], 0
    v_mfma_f32_16x16x32_bf16 v[208:211], v[80:83], v[12:15], 0
    v_mfma_f32_16x16x32_bf16 v[212:215], v[84:87], v[12:15], 0
    buffer_load_dwordx4 v[40:43], v1, s[8:11], s32 offen offset:2048 sc1
    s_waitcnt vmcnt(6)
    v_mfma_f32_16x16x32_bf16 v[184:187], v[88:91], v[16:19], v[184:187]
    v_mfma_f32_16x16x32_bf16 v[188:191], v[92:95], v[16:19], v[188:191]
    v_mfma_f32_16x16x32_bf16 v[192:195], v[96:99], v[16:19], v[192:195]
    v_mfma_f32_16x16x32_bf16 v[196:199], v[100:103], v[16:19], v[196:199]
    buffer_load_dwordx4 v[44:47], v1, s[8:11], s33 offen offset:2048 sc1
    s_waitcnt vmcnt(6)
    v_mfma_f32_16x16x32_bf16 v[200:203], v[88:91], v[20:23], v[200:203]
    v_mfma_f32_16x16x32_bf16 v[204:207], v[92:95], v[20:23], v[204:207]
    v_mfma_f32_16x16x32_bf16 v[208:211], v[96:99], v[20:23], v[208:211]
    v_mfma_f32_16x16x32_bf16 v[212:215], v[100:103], v[20:23], v[212:215]
    buffer_load_dwordx4 v[48:51], v1, s[8:11], s34 offen offset:2048 sc1
    s_waitcnt vmcnt(6)
    v_mfma_f32_16x16x32_bf16 v[184:187], v[104:107], v[24:27], v[184:187]
    v_mfma_f32_16x16x32_bf16 v[188:191], v[108:111], v[24:27], v[188:191]
    v_mfma_f32_16x16x32_bf16 v[192:195], v[112:115], v[24:27], v[192:195]
    v_mfma_f32_16x16x32_bf16 v[196:199], v[116:119], v[24:27], v[196:199]
    buffer_load_dwordx4 v[52:55], v1, s[8:11], s35 offen offset:2048 sc1
    buffer_load_dword v254, v252, s[8:11], 0 offen sc1
    s_waitcnt vmcnt(7)
    v_mfma_f32_16x16x32_bf16 v[200:203], v[104:107], v[28:31], v[200:203]
    v_mfma_f32_16x16x32_bf16 v[204:207], v[108:111], v[28:31], v[204:207]
    v_mfma_f32_16x16x32_bf16 v[208:211], v[112:115], v[28:31], v[208:211]
    v_mfma_f32_16x16x32_bf16 v[212:215], v[116:119], v[28:31], v[212:215]
    buffer_load_dwordx2 v[56:57], v253, s[8:11], s32 offen offset:3072 sc1
    s_waitcnt vmcnt(7)
    v_mfma_f32_16x16x32_bf16 v[184:187], v[120:123], v[32:35], v[184:187]
    v_mfma_f32_16x16x32_bf16 v[188:191], v[124:127], v[32:35], v[188:191]
    v_mfma_f32_16x16x32_bf16 v[192:195], v[128:131], v[32:35], v[192:195]
    v_mfma_f32_16x16x32_bf16 v[196:199], v[132:135], v[32:35], v[196:199]
    buffer_load_dwordx2 v[58:59], v253, s[8:11], s33 offen offset:3072 sc1
    s_waitcnt vmcnt(7)
    v_mfma_f32_16x16x32_bf16 v[200:203], v[120:123], v[36:39], v[200:203]
    v_mfma_f32_16x16x32_bf16 v[204:207], v[124:127], v[36:39], v[204:207]
    v_mfma_f32_16x16x32_bf16 v[208:211], v[128:131], v[36:39], v[208:211]
    v_mfma_f32_16x16x32_bf16 v[212:215], v[132:135], v[36:39], v[212:215]
    buffer_load_dwordx2 v[60:61], v253, s[8:11], s34 offen offset:3072 sc1
    s_setprio 2
    s_waitcnt vmcnt(6)
    v_swap_b32 v42, v44
    v_swap_b32 v43, v45
    s_nop 1
    v_mfma_f32_16x16x32_bf16 v[184:187], v[136:139], v[40:43], v[184:187]
    v_mfma_f32_16x16x32_bf16 v[188:191], v[140:143], v[40:43], v[188:191]
    v_mfma_f32_16x16x32_bf16 v[192:195], v[144:147], v[40:43], v[192:195]
    v_mfma_f32_16x16x32_bf16 v[196:199], v[148:151], v[40:43], v[196:199]
    buffer_load_dwordx2 v[62:63], v253, s[8:11], s35 offen offset:3072 sc1
    s_waitcnt vmcnt(7)
    v_mfma_f32_16x16x32_bf16 v[200:203], v[136:139], v[44:47], v[200:203]
    v_mfma_f32_16x16x32_bf16 v[204:207], v[140:143], v[44:47], v[204:207]
    v_mfma_f32_16x16x32_bf16 v[208:211], v[144:147], v[44:47], v[208:211]
    v_mfma_f32_16x16x32_bf16 v[212:215], v[148:151], v[44:47], v[212:215]
    s_waitcnt vmcnt(4)
    v_cmp_gt_u32 vcc, s47, v254
    s_cbranch_vccz E5B_84
    s_mov_b32 s46, 262144
POLL_85:
    buffer_load_dword v254, v252, s[8:11], 0 offen sc1
    s_waitcnt vmcnt(0)
    v_cmp_gt_u32 vcc, s47, v254
    s_cbranch_vccz POLLD_86
    s_sub_u32 s46, s46, 1
    s_cbranch_scc0 POLL_85
POLLD_86:
E5B_84:
    s_add_u32 s32, s32, 458752
    s_add_u32 s33, s33, 458752
    s_add_u32 s34, s34, 458752
    s_add_u32 s35, s35, 458752
    buffer_load_dwordx4 v[8:11], v1, s[8:11], s32 offen offset:0 sc1
    s_waitcnt vmcnt(6)
    v_swap_b32 v50, v52
    v_swap_b32 v51, v53
    s_nop 1
    v_mfma_f32_16x16x32_bf16 v[184:187], v[152:155], v[48:51], v[184:187]
    v_mfma_f32_16x16x32_bf16 v[188:191], v[156:159], v[48:51], v[188:191]
    v_mfma_f32_16x16x32_bf16 v[192:195], v[160:163], v[48:51], v[192:195]
    v_mfma_f32_16x16x32_bf16 v[196:199], v[164:167], v[48:51], v[196:199]
    buffer_load_dwordx4 v[12:15], v1, s[8:11], s32 offen offset:1024 sc1
    s_waitcnt vmcnt(7)
    v_mfma_f32_16x16x32_bf16 v[200:203], v[152:155], v[52:55], v[200:203]
    v_mfma_f32_16x16x32_bf16 v[204:207], v[156:159], v[52:55], v[204:207]
    v_mfma_f32_16x16x32_bf16 v[208:211], v[160:163], v[52:55], v[208:211]
    v_mfma_f32_16x16x32_bf16 v[212:215], v[164:167], v[52:55], v[212:215]
    buffer_load_dwordx4 v[16:19], v1, s[8:11], s33 offen offset:0 sc1
    buffer_load_dwordx4 v[20:23], v1, s[8:11], s33 offen offset:1024 sc1
    s_waitcnt vmcnt(4)
    v_swap_b32 v57, v58
    v_swap_b32 v61, v62
    v_swap_b32 v58, v60
    v_swap_b32 v59, v61
    s_nop 1
    v_mfma_f32_16x16x32_bf16 v[184:187], v[168:171], v[56:59], v[184:187]
    v_mfma_f32_16x16x32_bf16 v[188:191], v[172:175], v[56:59], v[188:191]
    v_mfma_f32_16x16x32_bf16 v[192:195], v[176:179], v[56:59], v[192:195]
    v_mfma_f32_16x16x32_bf16 v[196:199], v[180:183], v[56:59], v[196:199]
    buffer_load_dwordx4 v[24:27], v1, s[8:11], s34 offen offset:0 sc1
    buffer_load_dwordx4 v[28:31], v1, s[8:11], s34 offen offset:1024 sc1
    s_waitcnt vmcnt(6)
    v_mfma_f32_16x16x32_bf16 v[200:203], v[168:171], v[60:63], v[200:203]
    v_mfma_f32_16x16x32_bf16 v[204:207], v[172:175], v[60:63], v[204:207]
    v_mfma_f32_16x16x32_bf16 v[208:211], v[176:179], v[60:63], v[208:211]
    v_mfma_f32_16x16x32_bf16 v[212:215], v[180:183], v[60:63], v[212:215]
    buffer_load_dwordx4 v[32:35], v1, s[8:11], s35 offen offset:0 sc1
    s_waitcnt vmcnt(6)
    v_mfma_f32_16x16x32_bf16 v[216:219], v[72:75], v[8:11], 0
    v_mfma_f32_16x16x32_bf16 v[220:223], v[76:79], v[8:11], 0
    v_mfma_f32_16x16x32_bf16 v[224:227], v[80:83], v[8:11], 0
    v_mfma_f32_16x16x32_bf16 v[228:231], v[84:87], v[8:11], 0
    buffer_load_dwordx4 v[36:39], v1, s[8:11], s35 offen offset:1024 sc1
    s_waitcnt vmcnt(6)
    v_mfma_f32_16x16x32_bf16 v[232:235], v[72:75], v[12:15], 0
    v_mfma_f32_16x16x32_bf16 v[236:239], v[76:79], v[12:15], 0
    v_mfma_f32_16x16x32_bf16 v[240:243], v[80:83], v[12:15], 0
    v_mfma_f32_16x16x32_bf16 v[244:247], v[84:87], v[12:15], 0
    buffer_load_dwordx4 v[40:43], v1, s[8:11], s32 offen offset:2048 sc1
    s_setprio 1
    s_waitcnt vmcnt(6)
    v_mfma_f32_16x16x32_bf16 v[216:219], v[88:91], v[16:19], v[216:219]
    v_mfma_f32_16x16x32_bf16 v[220:223], v[92:95], v[16:19], v[220:223]
    v_mfma_f32_16x16x32_bf16 v[224:227], v[96:99], v[16:19], v[224:227]
    v_mfma_f32_16x16x32_bf16 v[228:231], v[100:103], v[16:19], v[228:231]
    buffer_load_dwordx4 v[44:47], v1, s[8:11], s33 offen offset:2048 sc1
    s_barrier
    ds_write_b128 v2, v[184:187] offset:0
    s_waitcnt vmcnt(6)
    v_mfma_f32_16x16x32_bf16 v[232:235], v[88:91], v[20:23], v[232:235]
    v_mfma_f32_16x16x32_bf16 v[236:239], v[92:95], v[20:23], v[236:239]
    v_mfma_f32_16x16x32_bf16 v[240:243], v[96:99], v[20:23], v[240:243]
    v_mfma_f32_16x16x32_bf16 v[244:247], v[100:103], v[20:23], v[244:247]
    buffer_load_dwordx4 v[48:51], v1, s[8:11], s34 offen offset:2048 sc1
    ds_write_b128 v2, v[188:191] offset:1024
    s_waitcnt vmcnt(6)
    v_mfma_f32_16x16x32_bf16 v[216:219], v[104:107], v[24:27], v[216:219]
    v_mfma_f32_16x16x32_bf16 v[220:223], v[108:111], v[24:27], v[220:223]
    v_mfma_f32_16x16x32_bf16 v[224:227], v[112:115], v[24:27], v[224:227]
    v_mfma_f32_16x16x32_bf16 v[228:231], v[116:119], v[24:27], v[228:231]
    buffer_load_dwordx4 v[52:55], v1, s[8:11], s35 offen offset:2048 sc1
    ds_read2_b64 v[8:11], v5 offset0:0 offset1:32
    ds_read2_b64 v[12:15], v5 offset0:64 offset1:96
    ds_read2_b64 v[16:19], v5 offset0:128 offset1:160
    ds_read2_b64 v[20:23], v5 offset0:192 offset1:224
    ds_write_b128 v3, v[192:195] offset:0
    s_waitcnt vmcnt(6)
    v_mfma_f32_16x16x32_bf16 v[232:235], v[104:107], v[28:31], v[232:235]
    v_mfma_f32_16x16x32_bf16 v[236:239], v[108:111], v[28:31], v[236:239]
    v_mfma_f32_16x16x32_bf16 v[240:243], v[112:115], v[28:31], v[240:243]
    v_mfma_f32_16x16x32_bf16 v[244:247], v[116:119], v[28:31], v[244:247]
    buffer_load_dwordx2 v[56:57], v253, s[8:11], s32 offen offset:3072 sc1
    ds_write_b128 v3, v[196:199] offset:1024
    s_waitcnt vmcnt(6)
    v_mfma_f32_16x16x32_bf16 v[216:219], v[120:123], v[32:35], v[216:219]
    v_mfma_f32_16x16x32_bf16 v[220:223], v[124:127], v[32:35], v[220:223]
    v_mfma_f32_16x16x32_bf16 v[224:227], v[128:131], v[32:35], v[224:227]
    v_mfma_f32_16x16x32_bf16 v[228:231], v[132:135], v[32:35], v[228:231]
    buffer_load_dwordx2 v[58:59], v253, s[8:11], s33 offen offset:3072 sc1
    ds_write_b128 v2, v[200:203] offset:16384
    s_waitcnt vmcnt(6)
    v_mfma_f32_16x16x32_bf16 v[232:235], v[120:123], v[36:39], v[232:235]
    v_mfma_f32_16x16x32_bf16 v[236:239], v[124:127], v[36:39], v[236:239]
    v_mfma_f32_16x16x32_bf16 v[240:243], v[128:131], v[36:39], v[240:243]
    v_mfma_f32_16x16x32_bf16 v[244:247], v[132:135], v[36:39], v[244:247]
    buffer_load_dwordx2 v[60:61], v253, s[8:11], s34 offen offset:3072 sc1
    ds_write_b128 v2, v[204:207] offset:17408
    s_waitcnt lgkmcnt(4)
    v_pk_add_f32 v[8:9], v[8:9], v[10:11]
    v_pk_add_f32 v[12:13], v[12:13], v[14:15]
    v_pk_add_f32 v[16:17], v[16:17], v[18:19]
    v_pk_add_f32 v[20:21], v[20:21], v[22:23]
    v_pk_add_f32 v[8:9], v[8:9], v[12:13]
    s_waitcnt vmcnt(5)
    v_swap_b32 v42, v44
    v_swap_b32 v43, v45
    s_nop 1
    v_mfma_f32_16x16x32_bf16 v[216:219], v[136:139], v[40:43], v[216:219]
    v_mfma_f32_16x16x32_bf16 v[220:223], v[140:143], v[40:43], v[220:223]
    v_mfma_f32_16x16x32_bf16 v[224:227], v[144:147], v[40:43], v[224:227]
    v_mfma_f32_16x16x32_bf16 v[228:231], v[148:151], v[40:43], v[228:231]
    buffer_load_dwordx2 v[62:63], v253, s[8:11], s35 offen offset:3072 sc1
    ds_write_b128 v3, v[208:211] offset:16384
    v_pk_add_f32 v[16:17], v[16:17], v[20:21]
    v_pk_add_f32 v[8:9], v[8:9], v[16:17]
    v_mov_b32 v10, v8
    v_mov_b32 v11, v9
    s_nop 1
    s_waitcnt vmcnt(6)
    v_mfma_f32_16x16x32_bf16 v[232:235], v[136:139], v[44:47], v[232:235]
    v_mfma_f32_16x16x32_bf16 v[236:239], v[140:143], v[44:47], v[236:239]
    v_mfma_f32_16x16x32_bf16 v[240:243], v[144:147], v[44:47], v[240:243]
    v_mfma_f32_16x16x32_bf16 v[244:247], v[148:151], v[44:47], v[244:247]
    buffer_load_dwordx4 v[64:67], v1, s[8:11], s40 offen sc1
    ds_write_b128 v3, v[212:215] offset:17408
    v_permlane32_swap_b32 v8, v10
    v_permlane32_swap_b32 v9, v11
    v_pk_add_f32 v[8:9], v[8:9], v[10:11]
    v_mov_b32 v10, v8
    v_mov_b32 v11, v9
    s_setprio 0
    s_waitcnt vmcnt(5)
    v_swap_b32 v50, v52
    v_swap_b32 v51, v53
    s_nop 1
    v_mfma_f32_16x16x32_bf16 v[216:219], v[152:155], v[48:51], v[216:219]
    v_mfma_f32_16x16x32_bf16 v[220:223], v[156:159], v[48:51], v[220:223]
    v_mfma_f32_16x16x32_bf16 v[224:227], v[160:163], v[48:51], v[224:227]
    v_mfma_f32_16x16x32_bf16 v[228:231], v[164:167], v[48:51], v[228:231]
    s_nop 1
    v_permlane16_swap_b32 v8, v10
    v_permlane16_swap_b32 v9, v11
    v_pk_add_f32 v[8:9], v[8:9], v[10:11]
    v_mul_f32 v8, 0x3b000000, v8
    s_waitcnt vmcnt(5)
    v_mfma_f32_16x16x32_bf16 v[232:235], v[152:155], v[52:55], v[232:235]
    v_mfma_f32_16x16x32_bf16 v[236:239], v[156:159], v[52:55], v[236:239]
    v_mfma_f32_16x16x32_bf16 v[240:243], v[160:163], v[52:55], v[240:243]
    v_mfma_f32_16x16x32_bf16 v[244:247], v[164:167], v[52:55], v[244:247]
    v_mul_f32 v9, 0x3b000000, v9
    v_fma_f32 v9, -v8, v8, v9
    v_max_f32 v9, 0, v9
    v_add_f32 v9, 925353388, v9
    v_rcp_f32 v8, v9
    s_waitcnt vmcnt(1)
    v_swap_b32 v57, v58
    v_swap_b32 v61, v62
    v_swap_b32 v58, v60
    v_swap_b32 v59, v61
    s_nop 1
    v_mfma_f32_16x16x32_bf16 v[216:219], v[168:171], v[56:59], v[216:219]
    v_mfma_f32_16x16x32_bf16 v[220:223], v[172:175], v[56:59], v[220:223]
    v_mfma_f32_16x16x32_bf16 v[224:227], v[176:179], v[56:59], v[224:227]
    v_mfma_f32_16x16x32_bf16 v[228:231], v[180:183], v[56:59], v[228:231]
    s_waitcnt vmcnt(1)
    v_mfma_f32_16x16x32_bf16 v[232:235], v[168:171], v[60:63], v[232:235]
    v_mfma_f32_16x16x32_bf16 v[236:239], v[172:175], v[60:63], v[236:239]
    v_mfma_f32_16x16x32_bf16 v[240:243], v[176:179], v[60:63], v[240:243]
    v_mfma_f32_16x16x32_bf16 v[244:247], v[180:183], v[60:63], v[244:247]
    ds_write_b128 v2, v[216:219] offset:32768
    ds_write_b128 v2, v[220:223] offset:33792
    ds_write_b128 v3, v[224:227] offset:32768
    ds_write_b128 v3, v[228:231] offset:33792
    s_waitcnt vmcnt(0)
    v_lshlrev_b32 v32, 16, v64
    v_and_b32 v33, 0xffff0000, v64
    v_lshlrev_b32 v34, 16, v65
    v_and_b32 v35, 0xffff0000, v65
    v_lshlrev_b32 v36, 16, v66
    v_and_b32 v37, 0xffff0000, v66
    v_lshlrev_b32 v38, 16, v67
    v_and_b32 v39, 0xffff0000, v67
    ds_write_b128 v2, v[232:235] offset:49152
    ds_write_b128 v2, v[236:239] offset:50176
    ds_write_b128 v255, v[240:243] offset:49152
    ds_write_b128 v255, v[244:247] offset:50176
    s_cmp_eq_u32 s17, 0
    s_cbranch_scc0 NOPF_87
    s_cmp_eq_u32 s48, 0
    s_cbranch_scc1 NOWKV_88
    s_lshr_b32 s30, s3, 1
    s_lshl_b32 s30, s30, 14
    s_add_u32 s30, s30, 524288
    buffer_load_dwordx4 v[68:71], v1, s[8:11], s30 offen offset:0
    buffer_load_dwordx4 v[72:75], v1, s[8:11], s30 offen offset:1024
    buffer_load_dwordx4 v[76:79], v1, s[8:11], s30 offen offset:2048
    buffer_load_dwordx4 v[80:83], v1, s[8:11], s30 offen offset:3072
    s_add_u32 s30, s30, 4096
    buffer_load_dwordx4 v[84:87], v1, s[8:11], s30 offen offset:0
    buffer_load_dwordx4 v[88:91], v1, s[8:11], s30 offen offset:1024
    buffer_load_dwordx4 v[92:95], v1, s[8:11], s30 offen offset:2048
    buffer_load_dwordx4 v[96:99], v1, s[8:11], s30 offen offset:3072
    s_add_u32 s30, s30, 4096
    buffer_load_dwordx4 v[100:103], v1, s[8:11], s30 offen offset:0
    buffer_load_dwordx4 v[104:107], v1, s[8:11], s30 offen offset:1024
    buffer_load_dwordx4 v[108:111], v1, s[8:11], s30 offen offset:2048
    buffer_load_dwordx4 v[112:115], v1, s[8:11], s30 offen offset:3072
    s_add_u32 s30, s30, 4096
    buffer_load_dwordx4 v[116:119], v1, s[8:11], s30 offen offset:0
    buffer_load_dwordx4 v[120:123], v1, s[8:11], s30 offen offset:1024
    buffer_load_dwordx4 v[124:127], v1, s[8:11], s30 offen offset:2048
    buffer_load_dwordx4 v[128:131], v1, s[8:11], s30 offen offset:3072
NOWKV_88:
NOPF_87:
    s_waitcnt lgkmcnt(0)
    s_barrier
    ds_read_b128 v[184:187], v4 offset:0
    ds_read_b128 v[188:191], v4 offset:1024
    ds_read_b128 v[192:195], v4 offset:2048
    ds_read_b128 v[196:199], v4 offset:3072
    ds_read_b128 v[200:203], v4 offset:4096
    ds_read_b128 v[204:207], v4 offset:5120
    ds_read_b128 v[208:211], v4 offset:6144
    ds_read_b128 v[212:215], v4 offset:7168
    ds_read_b128 v[216:219], v4 offset:8192
    ds_read_b128 v[220:223], v4 offset:9216
    ds_read_b128 v[224:227], v4 offset:10240
    ds_read_b128 v[228:231], v4 offset:11264
    ds_read_b128 v[232:235], v4 offset:12288
    ds_read_b128 v[236:239], v4 offset:13312
    ds_read_b128 v[240:243], v4 offset:14336
    ds_read_b128 v[244:247], v4 offset:15360
    s_waitcnt lgkmcnt(12)
    v_pk_add_f32 v[184:185], v[184:185], v[192:193]
    v_pk_add_f32 v[186:187], v[186:187], v[194:195]
    v_pk_add_f32 v[188:189], v[188:189], v[196:197]
    v_pk_add_f32 v[190:191], v[190:191], v[198:199]
    s_waitcnt lgkmcnt(10)
    v_pk_add_f32 v[184:185], v[184:185], v[200:201]
    v_pk_add_f32 v[186:187], v[186:187], v[202:203]
    v_pk_add_f32 v[188:189], v[188:189], v[204:205]
    v_pk_add_f32 v[190:191], v[190:191], v[206:207]
    s_waitcnt lgkmcnt(8)
    v_pk_add_f32 v[184:185], v[184:185], v[208:209]
    v_pk_add_f32 v[186:187], v[186:187], v[210:211]
    v_pk_add_f32 v[188:189], v[188:189], v[212:213]
    v_pk_add_f32 v[190:191], v[190:191], v[214:215]
    s_waitcnt lgkmcnt(6)
    v_pk_add_f32 v[184:185], v[184:185], v[216:217]
    v_pk_add_f32 v[186:187], v[186:187], v[218:219]
    v_pk_add_f32 v[188:189], v[188:189], v[220:221]
    v_pk_add_f32 v[190:191], v[190:191], v[222:223]
    s_waitcnt lgkmcnt(4)
    v_pk_add_f32 v[184:185], v[184:185], v[224:225]
    v_pk_add_f32 v[186:187], v[186:187], v[226:227]
    v_pk_add_f32 v[188:189], v[188:189], v[228:229]
    v_pk_add_f32 v[190:191], v[190:191], v[230:231]
    s_waitcnt lgkmcnt(2)
    v_pk_add_f32 v[184:185], v[184:185], v[232:233]
    v_pk_add_f32 v[186:187], v[186:187], v[234:235]
    v_pk_add_f32 v[188:189], v[188:189], v[236:237]
    v_pk_add_f32 v[190:191], v[190:191], v[238:239]
    s_waitcnt lgkmcnt(0)
    v_pk_add_f32 v[184:185], v[184:185], v[240:241]
    v_pk_add_f32 v[186:187], v[186:187], v[242:243]
    v_pk_add_f32 v[188:189], v[188:189], v[244:245]
    v_pk_add_f32 v[190:191], v[190:191], v[246:247]
    v_fma_f32 v184, v184, v8, v32
    v_fma_f32 v185, v185, v8, v33
    v_fma_f32 v186, v186, v8, v34
    v_fma_f32 v187, v187, v8, v35
    v_fma_f32 v188, v188, v8, v36
    v_fma_f32 v189, v189, v8, v37
    v_fma_f32 v190, v190, v8, v38
    v_fma_f32 v191, v191, v8, v39
    v_cvt_pk_bf16_f32 v248, v184, v185
    v_cvt_pk_bf16_f32 v249, v186, v187
    v_cvt_pk_bf16_f32 v250, v188, v189
    v_cvt_pk_bf16_f32 v251, v190, v191
    s_cmp_eq_u32 s17, 0
    s_cbranch_scc0 M_FINAL
    s_add_u32 s39, s39, 8388608
    s_cmp_eq_u32 s18, 0
    s_cbranch_scc1 GST_89
    buffer_store_dwordx4 v[248:251], v1, s[8:11], s39 offen
GSTB_90:
    v_lshrrev_b32 v4, 5, v0
    v_lshlrev_b32 v4, 2, v4
    v_lshl_add_u32 v3, v6, 3, v4
    s_lshl_b32 s40, s38, 14
    s_lshl_b32 s41, s37, 7
    s_add_u32 s40, s40, s41
    s_add_u32 s40, s40, 6881280
    v_dot2_f32_bf16 v252, v248, s27, 0
    v_dot2_f32_bf16 v253, v248, v248, 0
    v_dot2_f32_bf16 v252, v249, s27, v252
    v_dot2_f32_bf16 v253, v249, v249, v253
    v_dot2_f32_bf16 v252, v250, s27, v252
    v_dot2_f32_bf16 v253, v250, v250, v253
    v_dot2_f32_bf16 v252, v251, s27, v252
    v_dot2_f32_bf16 v253, v251, v251, v253
    s_nop 2
    v_permlane32_swap_b32 v252, v253
    v_add_f32 v252, v252, v253
    v_mov_b32 v253, v252
    s_nop 1
    v_permlane16_swap_b32 v252, v253
    v_add_f32 v252, v252, v253
    s_cmp_eq_u32 s18, 0
    s_cbranch_scc1 GST_91
    buffer_store_dword v252, v3, s[8:11], s40 offen
GSTB_92:
    s_add_u32 s30, s26, 4
    v_mov_b32 v4, s30
    v_mov_b32 v5, s25
    s_lshl_b32 s30, s24, 2
    s_and_b32 s31, s19, 3
    s_add_u32 s30, s30, s31
    s_lshl_b32 s30, s30, 3
    s_add_u32 s30, s30, s3
    s_lshl_b32 s30, s30, 3
    s_bfe_u32 s31, s19, 0x10002
    s_lshl_b32 s31, s31, 1
    s_add_u32 s30, s30, s31
    s_lshl_b32 s30, s30, 2
    s_add_u32 s30, s30, 7405568
    v_and_b32 v2, 1, v0
    v_bfe_u32 v3, v0, 1, 1
    v_lshl_add_u32 v2, v3, 2, v2
    v_lshl_add_u32 v2, v2, 2, s30
    s_mov_b32 s47, 4
    s_waitcnt vmcnt(0)
    s_mov_b64 exec, 1
    s_cmp_eq_u32 s93, 0
    s_cbranch_scc1 GST_93
    buffer_store_dword v4, v5, s[8:11], 0 offen
GSTB_94:
    s_mov_b64 exec, -1
    s_barrier
    s_mov_b32 s17, 1
    s_mov_b32 s26, 4
    s_mov_b32 s49, 6750208
    s_mov_b32 s56, s4
    s_mov_b32 s57, s5
    s_mov_b32 s58, 268435456
    s_mov_b32 s59, 0x20000
    s_nop 0
    s_branch M_LAYER
M_FINAL:
    v_lshlrev_b32 v3, 10, v6
    v_lshl_add_u32 v3, v7, 4, v3
    s_lshl_b32 s39, s37, 14
    s_lshl_b32 s40, s38, 6
    s_add_u32 s39, s39, s40
    buffer_store_dwordx4 v[248:251], v3, s[12:15], s39 offen nt
M_END:
    s_endpgm
M_UWAIT:
    s_mov_b32 s47, 1
    s_mov_b32 s46, 262144
POLL_1:
    buffer_load_dwordx4 v[8:11], v250, s[8:11], 0 offen sc1
    s_waitcnt vmcnt(0)
    v_min3_u32 v8, v8, v9, v10
    v_min_u32 v8, v8, v11
    v_cmp_gt_u32 vcc, s47, v8
    s_cbranch_vccz POLLD_2
    s_sub_u32 s46, s46, 1
    s_cbranch_scc0 POLL_1
POLLD_2:
    s_branch M_UWAIT_BACK
GST_65:
    buffer_store_dwordx4 v[252:255], v1, s[8:11], s30 offen sc1
    s_branch GSTB_66
GST_67:
    buffer_store_dword v4, v5, s[8:11], 0 offen sc1
    s_branch GSTB_68
M_SLOW:
    v_mov_b32 v4, 0xff800000
    s_mov_b32 s40, s49
    s_mov_b32 s41, 64
M_SLOW1_0:
    buffer_load_dwordx4 v[216:219], v1, s[8:11], s40 offen sc1
    s_waitcnt vmcnt(0)
    v_mfma_f32_32x32x16_bf16 v[152:167], v[216:219], v[240:243], 0
    s_nop 11
    v_max3_f32 v4, v4, v152, v153
    v_max3_f32 v4, v4, v154, v155
    v_max3_f32 v4, v4, v156, v157
    v_max3_f32 v4, v4, v158, v159
    v_max3_f32 v4, v4, v160, v161
    v_max3_f32 v4, v4, v162, v163
    v_max3_f32 v4, v4, v164, v165
    v_max3_f32 v4, v4, v166, v167
    s_add_u32 s40, s40, 2048
    s_sub_u32 s41, s41, 1
    s_cmp_lg_u32 s41, 0
    s_cbranch_scc1 M_SLOW1_0
    v_mov_b32 v5, v4
    s_nop 1
    v_permlane32_swap_b32 v4, v5
    v_max_f32 v4, v4, v5
    v_sub_f32 v168, 0, v4
    v_sub_f32 v169, 0, v4
    v_sub_f32 v170, 0, v4
    v_sub_f32 v171, 0, v4
    v_sub_f32 v172, 0, v4
    v_sub_f32 v173, 0, v4
    v_sub_f32 v174, 0, v4
    v_sub_f32 v175, 0, v4
    v_sub_f32 v176, 0, v4
    v_sub_f32 v177, 0, v4
    v_sub_f32 v178, 0, v4
    v_sub_f32 v179, 0, v4
    v_sub_f32 v180, 0, v4
    v_sub_f32 v181, 0, v4
    v_sub_f32 v182, 0, v4
    v_sub_f32 v183, 0, v4
    v_mov_b32 v184, 0
    v_mov_b32 v185, 0
    v_mov_b32 v186, 0
    v_mov_b32 v187, 0
    v_mov_b32 v188, 0
    v_mov_b32 v189, 0
    v_mov_b32 v190, 0
    v_mov_b32 v191, 0
    v_mov_b32 v192, 0
    v_mov_b32 v193, 0
    v_mov_b32 v194, 0
    v_mov_b32 v195, 0
    v_mov_b32 v196, 0
    v_mov_b32 v197, 0
    v_mov_b32 v198, 0
    v_mov_b32 v199, 0
    s_mov_b32 s40, s49
    s_mov_b32 s41, 64
M_SLOW2_0:
    buffer_load_dwordx4 v[216:219], v1, s[8:11], s40 offen sc1
    s_mov_b64 exec, s[28:29]
    buffer_load_dwordx4 v[224:227], v1, s[8:11], s40 offen offset:1024 sc1
    buffer_load_dwordx4 v[228:231], v1, s[8:11], s40 offen offset:1280 sc1
    s_mov_b64 exec, -1
    s_waitcnt vmcnt(0)
    v_mfma_f32_32x32x16_bf16 v[152:167], v[216:219], v[240:243], v[168:183]
    s_nop 11
    v_exp_f32 v152, v152
    v_exp_f32 v153, v153
    v_exp_f32 v154, v154
    v_exp_f32 v155, v155
    v_exp_f32 v156, v156
    v_exp_f32 v157, v157
    v_exp_f32 v158, v158
    v_exp_f32 v159, v159
    v_exp_f32 v160, v160
    v_exp_f32 v161, v161
    v_exp_f32 v162, v162
    v_exp_f32 v163, v163
    v_exp_f32 v164, v164
    v_exp_f32 v165, v165
    v_exp_f32 v166, v166
    v_exp_f32 v167, v167
    s_nop 1
    v_smfmac_f32_32x32x32_bf16 v[184:199], v[224:227], v[152:159], v252
    v_smfmac_f32_32x32x32_bf16 v[184:199], v[228:231], v[160:167], v252
    s_nop 11
    s_add_u32 s40, s40, 2048
    s_sub_u32 s41, s41, 1
    s_cmp_lg_u32 s41, 0
    s_cbranch_scc1 M_SLOW2_0
    v_mov_b32 v4, 0xff800000
    s_mov_b32 s40, s49
    s_mov_b32 s41, 64
M_SLOW1_1:
    buffer_load_dwordx4 v[216:219], v1, s[8:11], s40 offen sc1
    s_waitcnt vmcnt(0)
    v_mfma_f32_32x32x16_bf16 v[152:167], v[216:219], v[244:247], 0
    s_nop 11
    v_max3_f32 v4, v4, v152, v153
    v_max3_f32 v4, v4, v154, v155
    v_max3_f32 v4, v4, v156, v157
    v_max3_f32 v4, v4, v158, v159
    v_max3_f32 v4, v4, v160, v161
    v_max3_f32 v4, v4, v162, v163
    v_max3_f32 v4, v4, v164, v165
    v_max3_f32 v4, v4, v166, v167
    s_add_u32 s40, s40, 2048
    s_sub_u32 s41, s41, 1
    s_cmp_lg_u32 s41, 0
    s_cbranch_scc1 M_SLOW1_1
    v_mov_b32 v5, v4
    s_nop 1
    v_permlane32_swap_b32 v4, v5
    v_max_f32 v4, v4, v5
    v_sub_f32 v168, 0, v4
    v_sub_f32 v169, 0, v4
    v_sub_f32 v170, 0, v4
    v_sub_f32 v171, 0, v4
    v_sub_f32 v172, 0, v4
    v_sub_f32 v173, 0, v4
    v_sub_f32 v174, 0, v4
    v_sub_f32 v175, 0, v4
    v_sub_f32 v176, 0, v4
    v_sub_f32 v177, 0, v4
    v_sub_f32 v178, 0, v4
    v_sub_f32 v179, 0, v4
    v_sub_f32 v180, 0, v4
    v_sub_f32 v181, 0, v4
    v_sub_f32 v182, 0, v4
    v_sub_f32 v183, 0, v4
    v_mov_b32 v200, 0
    v_mov_b32 v201, 0
    v_mov_b32 v202, 0
    v_mov_b32 v203, 0
    v_mov_b32 v204, 0
    v_mov_b32 v205, 0
    v_mov_b32 v206, 0
    v_mov_b32 v207, 0
    v_mov_b32 v208, 0
    v_mov_b32 v209, 0
    v_mov_b32 v210, 0
    v_mov_b32 v211, 0
    v_mov_b32 v212, 0
    v_mov_b32 v213, 0
    v_mov_b32 v214, 0
    v_mov_b32 v215, 0
    s_mov_b32 s40, s49
    s_mov_b32 s41, 64
M_SLOW2_1:
    buffer_load_dwordx4 v[216:219], v1, s[8:11], s40 offen sc1
    s_mov_b64 exec, s[28:29]
    buffer_load_dwordx4 v[224:227], v1, s[8:11], s40 offen offset:1024 sc1
    buffer_load_dwordx4 v[228:231], v1, s[8:11], s40 offen offset:1280 sc1
    s_mov_b64 exec, -1
    s_waitcnt vmcnt(0)
    v_mfma_f32_32x32x16_bf16 v[152:167], v[216:219], v[244:247], v[168:183]
    s_nop 11
    v_exp_f32 v152, v152
    v_exp_f32 v153, v153
    v_exp_f32 v154, v154
    v_exp_f32 v155, v155
    v_exp_f32 v156, v156
    v_exp_f32 v157, v157
    v_exp_f32 v158, v158
    v_exp_f32 v159, v159
    v_exp_f32 v160, v160
    v_exp_f32 v161, v161
    v_exp_f32 v162, v162
    v_exp_f32 v163, v163
    v_exp_f32 v164, v164
    v_exp_f32 v165, v165
    v_exp_f32 v166, v166
    v_exp_f32 v167, v167
    s_nop 1
    v_smfmac_f32_32x32x32_bf16 v[200:215], v[224:227], v[152:159], v252
    v_smfmac_f32_32x32x32_bf16 v[200:215], v[228:231], v[160:167], v252
    s_nop 11
    s_add_u32 s40, s40, 2048
    s_sub_u32 s41, s41, 1
    s_cmp_lg_u32 s41, 0
    s_cbranch_scc1 M_SLOW2_1
    v_permlane16_swap_b32 v184, v200
    v_permlane16_swap_b32 v185, v201
    v_permlane16_swap_b32 v186, v202
    v_permlane16_swap_b32 v187, v203
    v_permlane16_swap_b32 v188, v204
    v_permlane16_swap_b32 v189, v205
    v_permlane16_swap_b32 v190, v206
    v_permlane16_swap_b32 v191, v207
    v_permlane16_swap_b32 v192, v208
    s_cmp_eq_u32 s45, 0
    s_cbranch_scc1 M_SLOW_BACK
    v_mov_b32 v184, v200
    v_mov_b32 v185, v201
    v_mov_b32 v186, v202
    v_mov_b32 v187, v203
    v_mov_b32 v188, v204
    v_mov_b32 v189, v205
    v_mov_b32 v190, v206
    v_mov_b32 v191, v207
    v_mov_b32 v192, v208
    s_branch M_SLOW_BACK
GST_71:
    buffer_store_dwordx4 v[168:171], v5, s[8:11], s39 offen sc1
    s_branch GSTB_72
GST_73:
    buffer_store_dword v172, v3, s[8:11], s40 offen sc1
    s_branch GSTB_74
GST_75:
    buffer_store_dword v176, v177, s[8:11], 0 offen sc1
    s_branch GSTB_76
GST_80:
    buffer_store_dword v254, v255, s[8:11], 0 offen sc1
    s_branch GSTB_81
GST_89:
    buffer_store_dwordx4 v[248:251], v1, s[8:11], s39 offen sc1
    s_branch GSTB_90
GST_91:
    buffer_store_dword v252, v3, s[8:11], s40 offen sc1
    s_branch GSTB_92
GST_93:
    buffer_store_dword v4, v5, s[8:11], 0 offen sc1
    s_branch GSTB_94
M_CODE_END:
.section .rodata,"a"
.p2align 6
.amdhsa_kernel interleave_layers__grouped_kv_mqa__glu_gated_reglu__prompt_kernel
  .amdhsa_next_free_vgpr 256
  .amdhsa_next_free_sgpr 102
  .amdhsa_accum_offset 256
  .amdhsa_group_segment_fixed_size 0
  .amdhsa_kernarg_size 96
  .amdhsa_user_sgpr_count 2
  .amdhsa_user_sgpr_kernarg_segment_ptr 1
  .amdhsa_system_sgpr_workgroup_id_x 1
.end_amdhsa_kernel
```
